```python
import torch

def _softmax(x, axis=-1):
    return torch.softmax(x, dim=axis)
def _gelu(x):
    return torch.nn.functional.gelu(x, approximate="tanh")
def _silu(x):
    return torch.nn.functional.silu(x)
def _sigmoid(x):
    return torch.sigmoid(x)
def _layernorm(x, axis=-1, eps=1e-5):
    m = x.mean(dim=axis, keepdim=True)
    v = x.var(dim=axis, keepdim=True, unbiased=False)
    return (x - m) / torch.sqrt(v + eps)
def _scatter_add(tgt, idx, src, axis=0):
    return tgt.clone().index_add_(axis, idx, src)
def _segment_sum(src, seg, n):
    out = torch.zeros((n,) + src.shape[1:], dtype=src.dtype)
    return out.index_add_(0, seg, src)
def _pad(x, pw):
    flat = tuple(v for pair in reversed(pw) for v in pair)
    return torch.nn.functional.pad(x, flat)

kernel_name = 'gated_mix__softmax_full_mha__ssm_conv_s4__prompt'

def setup_inputs():

    _w = (lambda a: (lambda t: t.to(torch.bfloat16) if t.is_floating_point() else t)(torch.as_tensor(a)))
    def _A_setup():
        B, S, D = 1, 2048, 640
        return {
            "x": _w((lambda *s: torch.randn(*s, dtype=torch.bfloat16) * 0.05)(B, S, D)),
            "wqkv": _w((lambda *s: torch.randn(*s, dtype=torch.bfloat16) * 0.8)(D, 3 * D)),
            "wo": _w((lambda *s: torch.randn(*s, dtype=torch.bfloat16) * 0.05)(D, D)),
        }
    _A_in = _A_setup()

    def _B_setup():
        B, L, D, N = 1, 2048, 640, 128
        A_re = -(lambda _x: torch.exp(torch.as_tensor(_x)))((lambda *s: torch.randn(*s, dtype=torch.bfloat16) * 6.4)(D, N))
        A_im = torch.pi * (lambda *s: torch.randn(*s, dtype=torch.bfloat16) * 0.1)(D, N)
        B_re = (lambda *s: torch.randn(*s, dtype=torch.bfloat16) * 0.2)(D, N)
        B_im = (lambda *s: torch.randn(*s, dtype=torch.bfloat16) * 0.2)(D, N)
        C_re = (lambda *s: torch.randn(*s, dtype=torch.bfloat16) * 0.2)(D, N)
        C_im = (lambda *s: torch.randn(*s, dtype=torch.bfloat16) * 0.2)(D, N)
        log_dt = (lambda *s: torch.randn(*s, dtype=torch.bfloat16) * 0.1)(D) * 0.5 - 4.0
        Dskip = (lambda *s: torch.randn(*s, dtype=torch.bfloat16) * 0.1)(D)
        return {
            "u": _w((lambda *s: torch.randn(*s, dtype=torch.bfloat16) * 0.05)(B, L, D)),
            "A_re": _w(A_re),
            "A_im": _w(A_im),
            "B_re": _w(B_re),
            "B_im": _w(B_im),
            "C_re": _w(C_re),
            "C_im": _w(C_im),
            "log_dt": _w(log_dt),
            "Dskip": _w(Dskip),
        }
    _B_in = _B_setup()

    return {
        "A_x": _A_in["x"],
        "A_wqkv": _A_in["wqkv"],
        "A_wo": _A_in["wo"],
        "B_u": _B_in["u"],
        "B_A_re": _B_in["A_re"],
        "B_A_im": _B_in["A_im"],
        "B_B_re": _B_in["B_re"],
        "B_B_im": _B_in["B_im"],
        "B_C_re": _B_in["C_re"],
        "B_C_im": _B_in["C_im"],
        "B_log_dt": _B_in["log_dt"],
        "B_Dskip": _B_in["Dskip"],
        "gate_w": _w((lambda *s: torch.randn(*s, dtype=torch.bfloat16) * 0.05)(640) * 16.0),
    }

def reference(A_x, A_wqkv, A_wo, B_u, B_A_re, B_A_im, B_B_re, B_B_im, B_C_re, B_C_im, B_log_dt, B_Dskip, gate_w):
    def _A_ref(x, wqkv, wo):
        B, S, D = x.shape
        H = 32; Dh = D // H
        qkv = (lambda x, *d: x.permute(*d))((x @ wqkv).reshape(B, S, 3, H, Dh), 2, 0, 3, 1, 4)
        q, k, v = qkv[0], qkv[1], qkv[2]
        scale = Dh ** -0.5
        scores = torch.einsum("bhqd,bhkd->bhqk", q, k) * scale
        p = _softmax(scores, axis=-1)
        o = torch.einsum("bhqk,bhkd->bhqd", p, v)
        return (lambda x, *d: x.permute(*d))(o, 0, 2, 1, 3).reshape(B, S, D) @ wo

    def _B_ref(u, A_re, A_im, B_re, B_im, C_re, C_im, log_dt, Dskip):
        Bsz, L, D = u.shape
        dt = torch.exp(log_dt)[:, None]
        A = A_re + 1j * A_im
        Bc = B_re + 1j * B_im
        Cc = C_re + 1j * C_im
        logdA = dt * A
        dB = dt * Bc
        l = (lambda x, dt: x.to(dt))(torch.arange(L), A_re.dtype)
        P = torch.exp(logdA[:, :, None] * l[None, None, :])
        K = torch.einsum("dn,dnl,dn->dl", Cc, P, dB).real
        L2 = 2 * L
        Kp = _pad(K, ((0, 0), (0, L)))
        up = (lambda x, *d: x.permute(*d))(u, 0, 2, 1)
        up = _pad(up, ((0, 0), (0, 0), (0, L)))
        Kf = (lambda x, axes=(-2,-1): torch.fft.rfft2(x.float(), dim=axes))(Kp[:, None, :], axes=(-2, -1))
        Uf = (lambda x, axes=(-2,-1): torch.fft.rfft2(x.float(), dim=axes))(up[:, :, None, :], axes=(-2, -1))
        Yf = Uf * Kf[None, :, :, :]
        y = (lambda x, s, axes=(-2,-1): torch.fft.irfft2(x, s=s, dim=axes).to(torch.bfloat16))(Yf, (1, L2), axes=(-2, -1))[:, :, 0, :L]
        y = (lambda x, *d: x.permute(*d))(y, 0, 2, 1) + u * Dskip[None, None, :]
        return y

    x = A_x
    g = _sigmoid((x * gate_w).sum(-1, keepdims=True))
    a = _A_ref(x, A_wqkv, A_wo)
    b = _B_ref(x, B_A_re, B_A_im, B_B_re, B_B_im, B_C_re, B_C_im, B_log_dt, B_Dskip)
    return g * a + (1 - g) * b
```

```asm
; @launch kernel=k1_kernel grid=(512,1,1) block=(512,1,1) lds=81920
; @launch kernel=k2_kernel grid=(256,1,1) block=(768,1,1) lds=163840
.amdgcn_target "amdgcn-amd-amdhsa--gfx950"
.text
.globl k1_kernel
.p2align 8
.type k1_kernel,@function
k1_kernel:
    s_cmp_ge_u32 s2, 512
    s_cbranch_scc1 K1_EXIT
    s_xor_b32 s2, s2, 256
    s_load_dwordx16 s[16:31], s[0:1], 0
    s_load_dwordx16 s[32:47], s[0:1], 64
    v_lshrrev_b32 v1, 6, v0
    v_and_b32 v0, 63, v0
    v_readfirstlane_b32 s3, v1
    s_cmp_ge_u32 s2, 240
    s_cbranch_scc1 K1_AUX
    s_and_b32 s4, s2, 7
    s_lshr_b32 s5, s2, 3
    s_and_b32 s6, s4, 1
    s_mul_i32 s6, s6, 30
    s_add_u32 s6, s6, s5
    s_lshr_b32 s7, s6, 2
    s_and_b32 s6, s6, 3
    s_lshr_b32 s63, s4, 1
    s_lshl_b32 s63, s63, 2
    s_add_u32 s8, s63, s6
    s_cmp_lt_u32 s3, 4
    s_cbranch_scc1 K1_CONS
    s_and_b32 s58, s4, 1
    s_mul_i32 s58, s58, 7
    s_sub_u32 s58, s7, s58
    s_mul_i32 s58, s58, 5
    s_lshr_b32 s58, s58, 2
    s_mul_i32 s59, s6, 5
    s_add_u32 s59, s59, 1
    s_lshr_b32 s59, s59, 1
    s_add_u32 s13, s58, s59
    s_sub_u32 s58, s13, 10
    s_cmp_ge_u32 s13, 10
    s_cselect_b32 s13, s58, s13
    s_lshl_b32 s58, s13, 1
    s_sub_u32 s58, 20, s58
    v_lshrrev_b32 v33, 4, v0
    s_and_b32 s11, s3, 1
    s_lshl_b32 s12, s11, 12
    s_cmp_ge_u32 s3, 6
    s_cbranch_scc1 K1_LDW
    v_lshrrev_b32 v32, 3, v0
    v_mul_u32_u24 v32, 1280, v32
    v_and_b32 v34, 7, v0
    v_xor_b32 v34, v34, v33
    v_lshl_add_u32 v4, v34, 4, v32
    v_xor_b32 v34, 4, v34
    v_lshl_add_u32 v5, v34, 4, v32
    v_add_u32 v5, 9216, v5
    v_add_u32 v6, 18432, v4
    v_add_u32 v7, 18432, v5
    s_mul_i32 s9, s8, 163840
    s_mul_i32 s11, s11, 40960
    s_add_u32 s9, s9, s11
    s_mov_b32 s10, 81920
    s_mov_b32 s11, 4294885504
    s_mov_b32 s60, 49152
    s_mov_b32 s61, 49152
    s_mov_b32 s15, 4
    s_mov_b32 s62, 16
    s_mov_b32 s56, -2
    s_mov_b32 s57, 4
    s_lshl_b32 s13, s13, 7
    s_add_u32 s9, s9, s13
    s_mov_b32 s59, 1280
    s_waitcnt lgkmcnt(0)
    s_mov_b32 s52, s16
    s_and_b32 s53, s17, 0xffff
    s_mov_b32 s54, 2621440
    s_mov_b32 s55, 0x20000
    s_branch K1_LD0
K1_LDW:
    v_mul_u32_u24 v32, 3840, v33
    v_and_b32 v34, 15, v0
    v_lshlrev_b32 v35, 2, v33
    v_xor_b32 v34, v34, v35
    v_lshl_add_u32 v4, v34, 4, v32
    v_add_u32 v5, 14336, v4
    v_add_u32 v6, 28672, v4
    v_add_u32 v7, 43008, v4
    s_lshl_b32 s9, s7, 8
    s_mul_i32 s11, s11, 61440
    s_add_u32 s9, s9, s11
    s_mov_b32 s10, 122880
    s_mov_b32 s11, 122880
    s_add_u32 s12, s12, 49152
    s_mov_b32 s60, 81920
    s_mov_b32 s61, 32768
    s_mov_b32 s15, 3
    s_mov_b32 s62, 17
    s_mov_b32 s56, -1
    s_mov_b32 s57, 3
    s_mul_i32 s13, s13, 245760
    s_add_u32 s9, s9, s13
    s_mov_b32 s59, 2457600
    s_waitcnt lgkmcnt(0)
    s_mov_b32 s52, s18
    s_and_b32 s53, s19, 0xffff
    s_mov_b32 s54, 2457600
    s_mov_b32 s55, 0x20000
K1_LD0:
    s_mov_b32 m0, s12
    s_nop 0
    buffer_load_dwordx4 v4, s[52:55], s9 offen offset:0 lds
    buffer_load_dwordx4 v5, s[52:55], s9 offen offset:1024 lds
    buffer_load_dwordx4 v6, s[52:55], s9 offen offset:2048 lds
    buffer_load_dwordx4 v7, s[52:55], s9 offen offset:3072 lds
    s_add_u32 s12, s12, 8192
    s_add_u32 s9, s9, s10
    s_sub_u32 s58, s58, 1
    s_cmp_eq_u32 s58, 0
    s_cselect_b32 s14, s59, 0
    s_sub_u32 s9, s9, s14
    s_mov_b32 s14, s10
    s_mov_b32 s10, s11
    s_mov_b32 s11, s14
    s_sub_u32 s14, s12, s61
    s_cmp_ge_u32 s12, s60
    s_cselect_b32 s12, s14, s12
    s_sub_u32 s15, s15, 1
    s_cmp_lg_u32 s15, 0
    s_cbranch_scc1 K1_LD0
    s_cmp_ge_u32 s3, 6
    s_cbranch_scc1 K1_LDW1
    s_waitcnt vmcnt(8)
    s_barrier
K1_LD1X:
    s_mov_b32 m0, s12
    s_nop 0
    buffer_load_dwordx4 v4, s[52:55], s9 offen offset:0 lds
    buffer_load_dwordx4 v5, s[52:55], s9 offen offset:1024 lds
    buffer_load_dwordx4 v6, s[52:55], s9 offen offset:2048 lds
    buffer_load_dwordx4 v7, s[52:55], s9 offen offset:3072 lds
    s_add_u32 s12, s12, 8192
    s_add_u32 s9, s9, s10
    s_sub_u32 s58, s58, 1
    s_cmp_eq_u32 s58, 0
    s_cselect_b32 s14, s59, 0
    s_sub_u32 s9, s9, s14
    s_mov_b32 s14, s10
    s_mov_b32 s10, s11
    s_mov_b32 s11, s14
    s_sub_u32 s14, s12, s61
    s_cmp_ge_u32 s12, s60
    s_cselect_b32 s12, s14, s12
    s_sub_u32 s62, s62, 1
    s_cmp_lg_u32 s62, 0
    s_waitcnt vmcnt(8)
    s_barrier
    s_cbranch_scc1 K1_LD1X
    s_waitcnt vmcnt(4)
    s_barrier
    s_waitcnt vmcnt(0)
    s_barrier
    s_endpgm
K1_LDW1:
    s_waitcnt vmcnt(8)
    s_barrier
K1_LD1W:
    s_mov_b32 m0, s12
    s_nop 0
    buffer_load_dwordx4 v4, s[52:55], s9 offen offset:0 lds
    buffer_load_dwordx4 v5, s[52:55], s9 offen offset:1024 lds
    buffer_load_dwordx4 v6, s[52:55], s9 offen offset:2048 lds
    buffer_load_dwordx4 v7, s[52:55], s9 offen offset:3072 lds
    s_add_u32 s12, s12, 8192
    s_add_u32 s9, s9, s10
    s_sub_u32 s58, s58, 1
    s_cmp_eq_u32 s58, 0
    s_cselect_b32 s14, s59, 0
    s_sub_u32 s9, s9, s14
    s_mov_b32 s14, s10
    s_mov_b32 s10, s11
    s_mov_b32 s11, s14
    s_sub_u32 s14, s12, s61
    s_cmp_ge_u32 s12, s60
    s_cselect_b32 s12, s14, s12
    s_sub_u32 s62, s62, 1
    s_cmp_lg_u32 s62, 0
    s_waitcnt vmcnt(8)
    s_barrier
    s_cbranch_scc1 K1_LD1W
    s_waitcnt vmcnt(4)
    s_barrier
    s_waitcnt vmcnt(0)
    s_barrier
    s_endpgm
K1_CONS:
    s_lshr_b32 s13, s3, 1
    s_and_b32 s14, s3, 1
    v_and_b32 v32, 31, v0
    v_lshrrev_b32 v33, 5, v0
    v_bfe_u32 v34, v0, 1, 3
    v_xor_b32 v34, v34, v33
    v_lshlrev_b32 v34, 4, v34
    v_lshl_add_u32 v34, v32, 7, v34
    s_lshl_b32 s12, s13, 13
    v_add_u32 v12, s12, v34
    v_xor_b32 v13, 32, v12
    v_xor_b32 v14, 64, v12
    v_xor_b32 v15, 96, v12
    v_mov_b32 v16, v12
    v_mov_b32 v17, v13
    v_mov_b32 v18, v14
    v_mov_b32 v19, v15
    v_bfe_u32 v34, v0, 2, 2
    v_lshl_add_u32 v35, v33, 3, v34
    v_lshlrev_b32 v35, 8, v35
    v_and_b32 v36, 3, v0
    v_lshl_add_u32 v35, v36, 3, v35
    v_bfe_u32 v36, v0, 4, 1
    v_lshl_add_u32 v35, v36, 5, v35
    v_add_u32 v35, 49152, v35
    s_lshl_b32 s12, s14, 1
    v_xor_b32 v36, s12, v34
    v_lshl_add_u32 v20, v36, 6, v35
    v_xor_b32 v21, 64, v20
    v_mov_b32 v22, v20
    v_mov_b32 v23, v21
    s_mov_b32 s59, 0
    v_mov_b32 v64, 0
    v_mov_b32 v65, 0
    v_mov_b32 v66, 0
    v_mov_b32 v67, 0
    v_mov_b32 v68, 0
    v_mov_b32 v69, 0
    v_mov_b32 v70, 0
    v_mov_b32 v71, 0
    v_mov_b32 v72, 0
    v_mov_b32 v73, 0
    v_mov_b32 v74, 0
    v_mov_b32 v75, 0
    v_mov_b32 v76, 0
    v_mov_b32 v77, 0
    v_mov_b32 v78, 0
    v_mov_b32 v79, 0
    v_mov_b32 v80, 0
    v_mov_b32 v81, 0
    v_mov_b32 v82, 0
    v_mov_b32 v83, 0
    v_mov_b32 v84, 0
    v_mov_b32 v85, 0
    v_mov_b32 v86, 0
    v_mov_b32 v87, 0
    v_mov_b32 v88, 0
    v_mov_b32 v89, 0
    v_mov_b32 v90, 0
    v_mov_b32 v91, 0
    v_mov_b32 v92, 0
    v_mov_b32 v93, 0
    v_mov_b32 v94, 0
    v_mov_b32 v95, 0
    v_mov_b32 v96, 0
    v_mov_b32 v97, 0
    v_mov_b32 v98, 0
    v_mov_b32 v99, 0
    v_mov_b32 v100, 0
    v_mov_b32 v101, 0
    v_mov_b32 v102, 0
    v_mov_b32 v103, 0
    v_mov_b32 v104, 0
    v_mov_b32 v105, 0
    v_mov_b32 v106, 0
    v_mov_b32 v107, 0
    v_mov_b32 v108, 0
    v_mov_b32 v109, 0
    v_mov_b32 v110, 0
    v_mov_b32 v111, 0
    v_mov_b32 v112, 0
    v_mov_b32 v113, 0
    v_mov_b32 v114, 0
    v_mov_b32 v115, 0
    v_mov_b32 v116, 0
    v_mov_b32 v117, 0
    v_mov_b32 v118, 0
    v_mov_b32 v119, 0
    v_mov_b32 v120, 0
    v_mov_b32 v121, 0
    v_mov_b32 v122, 0
    v_mov_b32 v123, 0
    v_mov_b32 v124, 0
    v_mov_b32 v125, 0
    v_mov_b32 v126, 0
    v_mov_b32 v127, 0
    s_lshl_b32 s15, s8, 2
    s_lshl_b32 s12, s13, 1
    s_add_u32 s15, s15, s12
    s_mul_i32 s15, s15, 1280
    s_waitcnt lgkmcnt(0)
    s_mov_b32 s48, s46
    s_and_b32 s49, s47, 0xffff
    s_mov_b32 s50, 22020096
    s_mov_b32 s51, 0x20000
    s_mov_b32 s17, 0
    s_cmp_ge_u32 s7, 10
    s_cbranch_scc1 K1_GEMM_V
    s_lshl_b32 s12, s7, 4
    s_lshl_b32 s60, s14, 3
    s_add_u32 s12, s12, s60
    v_add_u32 v34, s12, v33
    v_lshlrev_b32 v38, 4, v32
    v_lshl_add_u32 v39, v32, 3, 0
    v_add_u32 v39, 1024, v39
    s_mov_b32 s61, 81920
    s_add_u32 s63, s15, 81920
    v_add_u32 v35, 0, v34
    v_mul_u32_u24 v36, 205, v35
    v_lshrrev_b32 v36, 10, v36
    v_mul_u32_u24 v37, 5, v36
    v_sub_u32 v35, v35, v37
    v_lshlrev_b32 v36, 1, v36
    v_cmp_lt_u32 vcc, 2, v35
    v_subrev_u32 v37, 3, v35
    s_nop 0
    v_cndmask_b32 v37, v35, v37, vcc
    v_addc_co_u32 v36, vcc, 0, v36, vcc
    v_cmp_eq_u32 s[36:37], 2, v35
    v_lshl_add_u32 v37, v37, 9, v38
    s_nop 0
    v_cndmask_b32 v37, v37, v39, s[36:37]
    v_mad_u32_u24 v24, v36, s61, v37
    v_add_u32 v35, 2, v34
    v_mul_u32_u24 v36, 205, v35
    v_lshrrev_b32 v36, 10, v36
    v_mul_u32_u24 v37, 5, v36
    v_sub_u32 v35, v35, v37
    v_lshlrev_b32 v36, 1, v36
    v_cmp_lt_u32 vcc, 2, v35
    v_subrev_u32 v37, 3, v35
    s_nop 0
    v_cndmask_b32 v37, v35, v37, vcc
    v_addc_co_u32 v36, vcc, 0, v36, vcc
    v_cmp_eq_u32 s[38:39], 2, v35
    v_lshl_add_u32 v37, v37, 9, v38
    s_nop 0
    v_cndmask_b32 v37, v37, v39, s[38:39]
    v_mad_u32_u24 v25, v36, s61, v37
    v_add_u32 v35, 4, v34
    v_mul_u32_u24 v36, 205, v35
    v_lshrrev_b32 v36, 10, v36
    v_mul_u32_u24 v37, 5, v36
    v_sub_u32 v35, v35, v37
    v_lshlrev_b32 v36, 1, v36
    v_cmp_lt_u32 vcc, 2, v35
    v_subrev_u32 v37, 3, v35
    s_nop 0
    v_cndmask_b32 v37, v35, v37, vcc
    v_addc_co_u32 v36, vcc, 0, v36, vcc
    v_cmp_eq_u32 s[40:41], 2, v35
    v_lshl_add_u32 v37, v37, 9, v38
    s_nop 0
    v_cndmask_b32 v37, v37, v39, s[40:41]
    v_mad_u32_u24 v26, v36, s61, v37
    v_add_u32 v35, 6, v34
    v_mul_u32_u24 v36, 205, v35
    v_lshrrev_b32 v36, 10, v36
    v_mul_u32_u24 v37, 5, v36
    v_sub_u32 v35, v35, v37
    v_lshlrev_b32 v36, 1, v36
    v_cmp_lt_u32 vcc, 2, v35
    v_subrev_u32 v37, 3, v35
    s_nop 0
    v_cndmask_b32 v37, v35, v37, vcc
    v_addc_co_u32 v36, vcc, 0, v36, vcc
    v_cmp_eq_u32 s[42:43], 2, v35
    v_lshl_add_u32 v37, v37, 9, v38
    s_nop 0
    v_cndmask_b32 v37, v37, v39, s[42:43]
    v_mad_u32_u24 v27, v36, s61, v37
    s_mov_b32 s62, 1051011932
    s_cmp_ge_u32 s7, 5
    s_cselect_b32 s62, 1.0, s62
    s_barrier
    ds_read_b128 v[32:35], v16 offset:0
    ds_read_b128 v[36:39], v16 offset:4096
    ds_read_b64_tr_b16 v[48:49], v22 offset:0
    ds_read_b64_tr_b16 v[50:51], v22 offset:1024
    ds_read_b64_tr_b16 v[52:53], v23 offset:0
    ds_read_b64_tr_b16 v[54:55], v23 offset:1024
    ds_read_b128 v[40:43], v17 offset:0
    ds_read_b128 v[44:47], v17 offset:4096
    ds_read_b64_tr_b16 v[56:57], v22 offset:4096
    ds_read_b64_tr_b16 v[58:59], v22 offset:5120
    ds_read_b64_tr_b16 v[60:61], v23 offset:4096
    ds_read_b64_tr_b16 v[62:63], v23 offset:5120
    s_mov_b32 s16, 10
    s_waitcnt lgkmcnt(6)
K1_GL_qk:
    v_mfma_f32_32x32x16_bf16 v[64:79], v[48:51], v[32:35], v[64:79]
    s_add_u32 s59, s59, 8192
    s_cmp_eq_u32 s59, 32768
    s_cselect_b32 s59, 0, s59
    v_add_u32 v22, s59, v20
    v_add_u32 v23, s59, v21
    v_add_u32 v18, s17, v14
    v_add_u32 v19, s17, v15
    v_mfma_f32_32x32x16_bf16 v[80:95], v[52:55], v[32:35], v[80:95]
    s_waitcnt lgkmcnt(0)
    s_barrier
    ds_read_b128 v[32:35], v18 offset:0
    v_mfma_f32_32x32x16_bf16 v[96:111], v[48:51], v[36:39], v[96:111]
    ds_read_b64_tr_b16 v[48:49], v22 offset:0
    ds_read_b64_tr_b16 v[50:51], v22 offset:1024
    v_mfma_f32_32x32x16_bf16 v[112:127], v[52:55], v[36:39], v[112:127]
    ds_read_b128 v[36:39], v18 offset:4096
    ds_read_b64_tr_b16 v[52:53], v23 offset:0
    ds_read_b64_tr_b16 v[54:55], v23 offset:1024
    v_mfma_f32_32x32x16_bf16 v[64:79], v[56:59], v[40:43], v[64:79]
    v_mfma_f32_32x32x16_bf16 v[80:95], v[60:63], v[40:43], v[80:95]
    ds_read_b128 v[40:43], v19 offset:0
    v_mfma_f32_32x32x16_bf16 v[96:111], v[56:59], v[44:47], v[96:111]
    ds_read_b64_tr_b16 v[56:57], v22 offset:4096
    ds_read_b64_tr_b16 v[58:59], v22 offset:5120
    v_mfma_f32_32x32x16_bf16 v[112:127], v[60:63], v[44:47], v[112:127]
    ds_read_b128 v[44:47], v19 offset:4096
    ds_read_b64_tr_b16 v[60:61], v23 offset:4096
    ds_read_b64_tr_b16 v[62:63], v23 offset:5120
    s_waitcnt lgkmcnt(6)
    v_mfma_f32_32x32x16_bf16 v[64:79], v[48:51], v[32:35], v[64:79]
    s_add_u32 s59, s59, 8192
    s_cmp_eq_u32 s59, 32768
    s_cselect_b32 s59, 0, s59
    v_add_u32 v22, s59, v20
    v_add_u32 v23, s59, v21
    s_add_u32 s17, s17, 16384
    s_cmp_eq_u32 s17, 49152
    s_cselect_b32 s17, 0, s17
    v_add_u32 v16, s17, v12
    v_add_u32 v17, s17, v13
    v_mfma_f32_32x32x16_bf16 v[80:95], v[52:55], v[32:35], v[80:95]
    s_waitcnt lgkmcnt(0)
    s_barrier
    ds_read_b128 v[32:35], v16 offset:0
    v_mfma_f32_32x32x16_bf16 v[96:111], v[48:51], v[36:39], v[96:111]
    ds_read_b64_tr_b16 v[48:49], v22 offset:0
    ds_read_b64_tr_b16 v[50:51], v22 offset:1024
    v_mfma_f32_32x32x16_bf16 v[112:127], v[52:55], v[36:39], v[112:127]
    ds_read_b128 v[36:39], v16 offset:4096
    ds_read_b64_tr_b16 v[52:53], v23 offset:0
    ds_read_b64_tr_b16 v[54:55], v23 offset:1024
    v_mfma_f32_32x32x16_bf16 v[64:79], v[56:59], v[40:43], v[64:79]
    s_sub_u32 s16, s16, 1
    s_cmp_lg_u32 s16, 0
    v_mfma_f32_32x32x16_bf16 v[80:95], v[60:63], v[40:43], v[80:95]
    ds_read_b128 v[40:43], v17 offset:0
    v_mfma_f32_32x32x16_bf16 v[96:111], v[56:59], v[44:47], v[96:111]
    ds_read_b64_tr_b16 v[56:57], v22 offset:4096
    ds_read_b64_tr_b16 v[58:59], v22 offset:5120
    v_mfma_f32_32x32x16_bf16 v[112:127], v[60:63], v[44:47], v[112:127]
    ds_read_b128 v[44:47], v17 offset:4096
    ds_read_b64_tr_b16 v[60:61], v23 offset:4096
    ds_read_b64_tr_b16 v[62:63], v23 offset:5120
    s_waitcnt lgkmcnt(6)
    s_cbranch_scc1 K1_GL_qk
    v_pk_mul_f32 v[64:65], v[64:65], s[62:63] op_sel_hi:[1,0]
    v_pk_mul_f32 v[66:67], v[66:67], s[62:63] op_sel_hi:[1,0]
    v_pk_mul_f32 v[68:69], v[68:69], s[62:63] op_sel_hi:[1,0]
    v_pk_mul_f32 v[70:71], v[70:71], s[62:63] op_sel_hi:[1,0]
    v_cvt_pk_bf16_f32 v64, v64, v65
    v_cvt_pk_bf16_f32 v65, v66, v67
    v_cvt_pk_bf16_f32 v66, v68, v69
    v_cvt_pk_bf16_f32 v67, v70, v71
    s_nop 0
    v_permlane32_swap_b32 v64, v66
    v_permlane32_swap_b32 v65, v67
    s_andn2_b64 exec, -1, s[36:37]
    buffer_store_dwordx4 v[64:67], v24, s[48:51], s15 offen offset:0 sc0 sc1
    s_cmp_eq_u64 s[36:37], 0
    s_cbranch_scc1 K1_NM000
    s_mov_b64 exec, s[36:37]
    buffer_store_dwordx2 v[64:65], v24, s[48:51], s15 offen offset:0 sc0 sc1
    buffer_store_dwordx2 v[66:67], v24, s[48:51], s63 offen offset:0 sc0 sc1
K1_NM000:
    s_mov_b64 exec, -1
    v_pk_mul_f32 v[72:73], v[72:73], s[62:63] op_sel_hi:[1,0]
    v_pk_mul_f32 v[74:75], v[74:75], s[62:63] op_sel_hi:[1,0]
    v_pk_mul_f32 v[76:77], v[76:77], s[62:63] op_sel_hi:[1,0]
    v_pk_mul_f32 v[78:79], v[78:79], s[62:63] op_sel_hi:[1,0]
    v_cvt_pk_bf16_f32 v72, v72, v73
    v_cvt_pk_bf16_f32 v73, v74, v75
    v_cvt_pk_bf16_f32 v74, v76, v77
    v_cvt_pk_bf16_f32 v75, v78, v79
    s_nop 0
    v_permlane32_swap_b32 v72, v74
    v_permlane32_swap_b32 v73, v75
    s_andn2_b64 exec, -1, s[38:39]
    buffer_store_dwordx4 v[72:75], v25, s[48:51], s15 offen offset:0 sc0 sc1
    s_cmp_eq_u64 s[38:39], 0
    s_cbranch_scc1 K1_NM001
    s_mov_b64 exec, s[38:39]
    buffer_store_dwordx2 v[72:73], v25, s[48:51], s15 offen offset:0 sc0 sc1
    buffer_store_dwordx2 v[74:75], v25, s[48:51], s63 offen offset:0 sc0 sc1
K1_NM001:
    s_mov_b64 exec, -1
    v_pk_mul_f32 v[80:81], v[80:81], s[62:63] op_sel_hi:[1,0]
    v_pk_mul_f32 v[82:83], v[82:83], s[62:63] op_sel_hi:[1,0]
    v_pk_mul_f32 v[84:85], v[84:85], s[62:63] op_sel_hi:[1,0]
    v_pk_mul_f32 v[86:87], v[86:87], s[62:63] op_sel_hi:[1,0]
    v_cvt_pk_bf16_f32 v80, v80, v81
    v_cvt_pk_bf16_f32 v81, v82, v83
    v_cvt_pk_bf16_f32 v82, v84, v85
    v_cvt_pk_bf16_f32 v83, v86, v87
    s_nop 0
    v_permlane32_swap_b32 v80, v82
    v_permlane32_swap_b32 v81, v83
    s_andn2_b64 exec, -1, s[40:41]
    buffer_store_dwordx4 v[80:83], v26, s[48:51], s15 offen offset:0 sc0 sc1
    s_cmp_eq_u64 s[40:41], 0
    s_cbranch_scc1 K1_NM010
    s_mov_b64 exec, s[40:41]
    buffer_store_dwordx2 v[80:81], v26, s[48:51], s15 offen offset:0 sc0 sc1
    buffer_store_dwordx2 v[82:83], v26, s[48:51], s63 offen offset:0 sc0 sc1
K1_NM010:
    s_mov_b64 exec, -1
    v_pk_mul_f32 v[88:89], v[88:89], s[62:63] op_sel_hi:[1,0]
    v_pk_mul_f32 v[90:91], v[90:91], s[62:63] op_sel_hi:[1,0]
    v_pk_mul_f32 v[92:93], v[92:93], s[62:63] op_sel_hi:[1,0]
    v_pk_mul_f32 v[94:95], v[94:95], s[62:63] op_sel_hi:[1,0]
    v_cvt_pk_bf16_f32 v88, v88, v89
    v_cvt_pk_bf16_f32 v89, v90, v91
    v_cvt_pk_bf16_f32 v90, v92, v93
    v_cvt_pk_bf16_f32 v91, v94, v95
    s_nop 0
    v_permlane32_swap_b32 v88, v90
    v_permlane32_swap_b32 v89, v91
    s_andn2_b64 exec, -1, s[42:43]
    buffer_store_dwordx4 v[88:91], v27, s[48:51], s15 offen offset:0 sc0 sc1
    s_cmp_eq_u64 s[42:43], 0
    s_cbranch_scc1 K1_NM011
    s_mov_b64 exec, s[42:43]
    buffer_store_dwordx2 v[88:89], v27, s[48:51], s15 offen offset:0 sc0 sc1
    buffer_store_dwordx2 v[90:91], v27, s[48:51], s63 offen offset:0 sc0 sc1
K1_NM011:
    s_mov_b64 exec, -1
    v_pk_mul_f32 v[96:97], v[96:97], s[62:63] op_sel_hi:[1,0]
    v_pk_mul_f32 v[98:99], v[98:99], s[62:63] op_sel_hi:[1,0]
    v_pk_mul_f32 v[100:101], v[100:101], s[62:63] op_sel_hi:[1,0]
    v_pk_mul_f32 v[102:103], v[102:103], s[62:63] op_sel_hi:[1,0]
    v_cvt_pk_bf16_f32 v96, v96, v97
    v_cvt_pk_bf16_f32 v97, v98, v99
    v_cvt_pk_bf16_f32 v98, v100, v101
    v_cvt_pk_bf16_f32 v99, v102, v103
    s_nop 0
    v_permlane32_swap_b32 v96, v98
    v_permlane32_swap_b32 v97, v99
    s_andn2_b64 exec, -1, s[36:37]
    buffer_store_dwordx4 v[96:99], v24, s[48:51], s15 offen offset:1280 sc0 sc1
    s_cmp_eq_u64 s[36:37], 0
    s_cbranch_scc1 K1_NM100
    s_mov_b64 exec, s[36:37]
    buffer_store_dwordx2 v[96:97], v24, s[48:51], s15 offen offset:1280 sc0 sc1
    buffer_store_dwordx2 v[98:99], v24, s[48:51], s63 offen offset:1280 sc0 sc1
K1_NM100:
    s_mov_b64 exec, -1
    v_pk_mul_f32 v[104:105], v[104:105], s[62:63] op_sel_hi:[1,0]
    v_pk_mul_f32 v[106:107], v[106:107], s[62:63] op_sel_hi:[1,0]
    v_pk_mul_f32 v[108:109], v[108:109], s[62:63] op_sel_hi:[1,0]
    v_pk_mul_f32 v[110:111], v[110:111], s[62:63] op_sel_hi:[1,0]
    v_cvt_pk_bf16_f32 v104, v104, v105
    v_cvt_pk_bf16_f32 v105, v106, v107
    v_cvt_pk_bf16_f32 v106, v108, v109
    v_cvt_pk_bf16_f32 v107, v110, v111
    s_nop 0
    v_permlane32_swap_b32 v104, v106
    v_permlane32_swap_b32 v105, v107
    s_andn2_b64 exec, -1, s[38:39]
    buffer_store_dwordx4 v[104:107], v25, s[48:51], s15 offen offset:1280 sc0 sc1
    s_cmp_eq_u64 s[38:39], 0
    s_cbranch_scc1 K1_NM101
    s_mov_b64 exec, s[38:39]
    buffer_store_dwordx2 v[104:105], v25, s[48:51], s15 offen offset:1280 sc0 sc1
    buffer_store_dwordx2 v[106:107], v25, s[48:51], s63 offen offset:1280 sc0 sc1
K1_NM101:
    s_mov_b64 exec, -1
    v_pk_mul_f32 v[112:113], v[112:113], s[62:63] op_sel_hi:[1,0]
    v_pk_mul_f32 v[114:115], v[114:115], s[62:63] op_sel_hi:[1,0]
    v_pk_mul_f32 v[116:117], v[116:117], s[62:63] op_sel_hi:[1,0]
    v_pk_mul_f32 v[118:119], v[118:119], s[62:63] op_sel_hi:[1,0]
    v_cvt_pk_bf16_f32 v112, v112, v113
    v_cvt_pk_bf16_f32 v113, v114, v115
    v_cvt_pk_bf16_f32 v114, v116, v117
    v_cvt_pk_bf16_f32 v115, v118, v119
    s_nop 0
    v_permlane32_swap_b32 v112, v114
    v_permlane32_swap_b32 v113, v115
    s_andn2_b64 exec, -1, s[40:41]
    buffer_store_dwordx4 v[112:115], v26, s[48:51], s15 offen offset:1280 sc0 sc1
    s_cmp_eq_u64 s[40:41], 0
    s_cbranch_scc1 K1_NM110
    s_mov_b64 exec, s[40:41]
    buffer_store_dwordx2 v[112:113], v26, s[48:51], s15 offen offset:1280 sc0 sc1
    buffer_store_dwordx2 v[114:115], v26, s[48:51], s63 offen offset:1280 sc0 sc1
K1_NM110:
    s_mov_b64 exec, -1
    v_pk_mul_f32 v[120:121], v[120:121], s[62:63] op_sel_hi:[1,0]
    v_pk_mul_f32 v[122:123], v[122:123], s[62:63] op_sel_hi:[1,0]
    v_pk_mul_f32 v[124:125], v[124:125], s[62:63] op_sel_hi:[1,0]
    v_pk_mul_f32 v[126:127], v[126:127], s[62:63] op_sel_hi:[1,0]
    v_cvt_pk_bf16_f32 v120, v120, v121
    v_cvt_pk_bf16_f32 v121, v122, v123
    v_cvt_pk_bf16_f32 v122, v124, v125
    v_cvt_pk_bf16_f32 v123, v126, v127
    s_nop 0
    v_permlane32_swap_b32 v120, v122
    v_permlane32_swap_b32 v121, v123
    s_andn2_b64 exec, -1, s[42:43]
    buffer_store_dwordx4 v[120:123], v27, s[48:51], s15 offen offset:1280 sc0 sc1
    s_cmp_eq_u64 s[42:43], 0
    s_cbranch_scc1 K1_NM111
    s_mov_b64 exec, s[42:43]
    buffer_store_dwordx2 v[120:121], v27, s[48:51], s15 offen offset:1280 sc0 sc1
    buffer_store_dwordx2 v[122:123], v27, s[48:51], s63 offen offset:1280 sc0 sc1
K1_NM111:
    s_mov_b64 exec, -1
    s_endpgm
K1_GEMM_V:
    s_sub_u32 s12, s7, 10
    s_lshl_b32 s12, s12, 7
    s_lshl_b32 s60, s14, 6
    s_add_u32 s12, s12, s60
    s_mov_b32 s61, 81920
    v_lshlrev_b32 v38, 4, v33
    v_add_u32 v35, s12, v32
    v_mul_u32_u24 v36, 3277, v35
    v_lshrrev_b32 v36, 16, v36
    v_mul_u32_u24 v37, 20, v36
    v_sub_u32 v35, v35, v37
    v_lshl_add_u32 v37, v35, 5, v38
    v_mad_u32_u24 v24, v36, s61, v37
    v_add_u32 v35, s12, v32
    v_add_u32 v35, 32, v35
    v_mul_u32_u24 v36, 3277, v35
    v_lshrrev_b32 v36, 16, v36
    v_mul_u32_u24 v37, 20, v36
    v_sub_u32 v35, v35, v37
    v_lshl_add_u32 v37, v35, 5, v38
    v_mad_u32_u24 v25, v36, s61, v37
    s_add_u32 s15, s15, 5242880
    s_barrier
    ds_read_b128 v[32:35], v16 offset:0
    ds_read_b128 v[36:39], v16 offset:4096
    ds_read_b64_tr_b16 v[48:49], v22 offset:0
    ds_read_b64_tr_b16 v[50:51], v22 offset:1024
    ds_read_b64_tr_b16 v[52:53], v23 offset:0
    ds_read_b64_tr_b16 v[54:55], v23 offset:1024
    ds_read_b128 v[40:43], v17 offset:0
    ds_read_b128 v[44:47], v17 offset:4096
    ds_read_b64_tr_b16 v[56:57], v22 offset:4096
    ds_read_b64_tr_b16 v[58:59], v22 offset:5120
    ds_read_b64_tr_b16 v[60:61], v23 offset:4096
    ds_read_b64_tr_b16 v[62:63], v23 offset:5120
    s_mov_b32 s16, 10
    s_waitcnt lgkmcnt(6)
K1_GL_v:
    v_mfma_f32_32x32x16_bf16 v[64:79], v[32:35], v[48:51], v[64:79]
    s_add_u32 s59, s59, 8192
    s_cmp_eq_u32 s59, 32768
    s_cselect_b32 s59, 0, s59
    v_add_u32 v22, s59, v20
    v_add_u32 v23, s59, v21
    v_add_u32 v18, s17, v14
    v_add_u32 v19, s17, v15
    v_mfma_f32_32x32x16_bf16 v[80:95], v[32:35], v[52:55], v[80:95]
    s_waitcnt lgkmcnt(0)
    s_barrier
    ds_read_b128 v[32:35], v18 offset:0
    v_mfma_f32_32x32x16_bf16 v[96:111], v[36:39], v[48:51], v[96:111]
    ds_read_b64_tr_b16 v[48:49], v22 offset:0
    ds_read_b64_tr_b16 v[50:51], v22 offset:1024
    v_mfma_f32_32x32x16_bf16 v[112:127], v[36:39], v[52:55], v[112:127]
    ds_read_b128 v[36:39], v18 offset:4096
    ds_read_b64_tr_b16 v[52:53], v23 offset:0
    ds_read_b64_tr_b16 v[54:55], v23 offset:1024
    v_mfma_f32_32x32x16_bf16 v[64:79], v[40:43], v[56:59], v[64:79]
    v_mfma_f32_32x32x16_bf16 v[80:95], v[40:43], v[60:63], v[80:95]
    ds_read_b128 v[40:43], v19 offset:0
    v_mfma_f32_32x32x16_bf16 v[96:111], v[44:47], v[56:59], v[96:111]
    ds_read_b64_tr_b16 v[56:57], v22 offset:4096
    ds_read_b64_tr_b16 v[58:59], v22 offset:5120
    v_mfma_f32_32x32x16_bf16 v[112:127], v[44:47], v[60:63], v[112:127]
    ds_read_b128 v[44:47], v19 offset:4096
    ds_read_b64_tr_b16 v[60:61], v23 offset:4096
    ds_read_b64_tr_b16 v[62:63], v23 offset:5120
    s_waitcnt lgkmcnt(6)
    v_mfma_f32_32x32x16_bf16 v[64:79], v[32:35], v[48:51], v[64:79]
    s_add_u32 s59, s59, 8192
    s_cmp_eq_u32 s59, 32768
    s_cselect_b32 s59, 0, s59
    v_add_u32 v22, s59, v20
    v_add_u32 v23, s59, v21
    s_add_u32 s17, s17, 16384
    s_cmp_eq_u32 s17, 49152
    s_cselect_b32 s17, 0, s17
    v_add_u32 v16, s17, v12
    v_add_u32 v17, s17, v13
    v_mfma_f32_32x32x16_bf16 v[80:95], v[32:35], v[52:55], v[80:95]
    s_waitcnt lgkmcnt(0)
    s_barrier
    ds_read_b128 v[32:35], v16 offset:0
    v_mfma_f32_32x32x16_bf16 v[96:111], v[36:39], v[48:51], v[96:111]
    ds_read_b64_tr_b16 v[48:49], v22 offset:0
    ds_read_b64_tr_b16 v[50:51], v22 offset:1024
    v_mfma_f32_32x32x16_bf16 v[112:127], v[36:39], v[52:55], v[112:127]
    ds_read_b128 v[36:39], v16 offset:4096
    ds_read_b64_tr_b16 v[52:53], v23 offset:0
    ds_read_b64_tr_b16 v[54:55], v23 offset:1024
    v_mfma_f32_32x32x16_bf16 v[64:79], v[40:43], v[56:59], v[64:79]
    s_sub_u32 s16, s16, 1
    s_cmp_lg_u32 s16, 0
    v_mfma_f32_32x32x16_bf16 v[80:95], v[40:43], v[60:63], v[80:95]
    ds_read_b128 v[40:43], v17 offset:0
    v_mfma_f32_32x32x16_bf16 v[96:111], v[44:47], v[56:59], v[96:111]
    ds_read_b64_tr_b16 v[56:57], v22 offset:4096
    ds_read_b64_tr_b16 v[58:59], v22 offset:5120
    v_mfma_f32_32x32x16_bf16 v[112:127], v[44:47], v[60:63], v[112:127]
    ds_read_b128 v[44:47], v17 offset:4096
    ds_read_b64_tr_b16 v[60:61], v23 offset:4096
    ds_read_b64_tr_b16 v[62:63], v23 offset:5120
    s_waitcnt lgkmcnt(6)
    s_cbranch_scc1 K1_GL_v
    v_cvt_pk_bf16_f32 v64, v64, v65
    v_cvt_pk_bf16_f32 v65, v66, v67
    v_cvt_pk_bf16_f32 v66, v68, v69
    v_cvt_pk_bf16_f32 v67, v70, v71
    buffer_store_dwordx4 v[64:67], v24, s[48:51], s15 offen offset:0 sc0 sc1
    v_cvt_pk_bf16_f32 v72, v72, v73
    v_cvt_pk_bf16_f32 v73, v74, v75
    v_cvt_pk_bf16_f32 v74, v76, v77
    v_cvt_pk_bf16_f32 v75, v78, v79
    buffer_store_dwordx4 v[72:75], v24, s[48:51], s15 offen offset:640 sc0 sc1
    v_cvt_pk_bf16_f32 v80, v80, v81
    v_cvt_pk_bf16_f32 v81, v82, v83
    v_cvt_pk_bf16_f32 v82, v84, v85
    v_cvt_pk_bf16_f32 v83, v86, v87
    buffer_store_dwordx4 v[80:83], v25, s[48:51], s15 offen offset:0 sc0 sc1
    v_cvt_pk_bf16_f32 v88, v88, v89
    v_cvt_pk_bf16_f32 v89, v90, v91
    v_cvt_pk_bf16_f32 v90, v92, v93
    v_cvt_pk_bf16_f32 v91, v94, v95
    buffer_store_dwordx4 v[88:91], v25, s[48:51], s15 offen offset:640 sc0 sc1
    v_cvt_pk_bf16_f32 v96, v96, v97
    v_cvt_pk_bf16_f32 v97, v98, v99
    v_cvt_pk_bf16_f32 v98, v100, v101
    v_cvt_pk_bf16_f32 v99, v102, v103
    buffer_store_dwordx4 v[96:99], v24, s[48:51], s15 offen offset:1280 sc0 sc1
    v_cvt_pk_bf16_f32 v104, v104, v105
    v_cvt_pk_bf16_f32 v105, v106, v107
    v_cvt_pk_bf16_f32 v106, v108, v109
    v_cvt_pk_bf16_f32 v107, v110, v111
    buffer_store_dwordx4 v[104:107], v24, s[48:51], s15 offen offset:1920 sc0 sc1
    v_cvt_pk_bf16_f32 v112, v112, v113
    v_cvt_pk_bf16_f32 v113, v114, v115
    v_cvt_pk_bf16_f32 v114, v116, v117
    v_cvt_pk_bf16_f32 v115, v118, v119
    buffer_store_dwordx4 v[112:115], v25, s[48:51], s15 offen offset:1280 sc0 sc1
    v_cvt_pk_bf16_f32 v120, v120, v121
    v_cvt_pk_bf16_f32 v121, v122, v123
    v_cvt_pk_bf16_f32 v122, v124, v125
    v_cvt_pk_bf16_f32 v123, v126, v127
    buffer_store_dwordx4 v[120:123], v25, s[48:51], s15 offen offset:1920 sc0 sc1
    s_endpgm
K1_AUX:
    s_cmp_ge_u32 s3, 6
    s_cbranch_scc1 K1_EXIT
    s_sub_u32 s5, s2, 256
    s_cmp_ge_u32 s5, 240
    s_cbranch_scc1 K1_AUXA
    s_cmp_ge_u32 s3, 4
    s_cbranch_scc1 K1_EXIT
    s_lshl_b32 s4, s5, 1
    s_add_u32 s4, s4, s3
    s_and_b32 s6, s5, 7
    s_lshr_b32 s7, s5, 3
    s_waitcnt lgkmcnt(0)
    s_mov_b32 s48, s46
    s_and_b32 s49, s47, 0xffff
    s_mov_b32 s50, 22020096
    s_mov_b32 s51, 0x20000
    s_cmp_lt_u32 s3, 2
    s_cbranch_scc1 K1_KGEN
    s_mul_i32 s4, s6, 40
    s_add_u32 s4, s4, s7
    s_cmp_eq_u32 s3, 2
    s_cbranch_scc1 K1_TRANS
    s_add_u32 s4, s4, 30
    s_cmp_lt_u32 s7, 10
    s_cbranch_scc1 K1_TRANS
    s_lshl_b32 s4, s6, 3
    s_add_u32 s4, s4, s7
    s_sub_u32 s4, s4, 10
    s_cmp_lt_u32 s7, 18
    s_cbranch_scc1 K1_GATE
    s_sub_u32 s4, s5, 144
    s_cmp_lt_u32 s7, 28
    s_cbranch_scc1 K1_WOT
    s_endpgm
K1_AUXA:
    s_waitcnt lgkmcnt(0)
    s_mov_b32 s48, s46
    s_and_b32 s49, s47, 0xffff
    s_mov_b32 s50, 22020096
    s_mov_b32 s51, 0x20000
    s_and_b32 s4, s2, 15
    s_lshr_b32 s5, s2, 8
    s_lshl_b32 s5, s5, 4
    s_add_u32 s4, s4, s5
    s_mul_i32 s4, s4, 5
    s_add_u32 s4, s4, s3
    s_add_u32 s4, s4, 480
    s_cmp_lt_u32 s3, 5
    s_cbranch_scc1 K1_KGEN
    s_cmp_lg_u32 s2, 511
    s_cbranch_scc1 K1_EXIT
    v_mov_b32 v4, 0
    v_mov_b32 v5, 0
    v_mov_b32 v6, 0
    v_mov_b32 v7, 0
    v_lshlrev_b32 v2, 4, v0
    s_mov_b32 s4, 21954560
    buffer_store_dwordx4 v[4:7], v2, s[48:51], s4 offen
    s_add_u32 s4, s4, 1024
    buffer_store_dwordx4 v[4:7], v2, s[48:51], s4 offen
    s_add_u32 s4, s4, 1024
    buffer_store_dwordx4 v[4:7], v2, s[48:51], s4 offen
    s_add_u32 s4, s4, 1024
    buffer_store_dwordx4 v[4:7], v2, s[48:51], s4 offen
    s_add_u32 s4, s4, 1024
    buffer_store_dwordx4 v[4:7], v2, s[48:51], s4 offen
    s_add_u32 s4, s4, 1024
    buffer_store_dwordx4 v[4:7], v2, s[48:51], s4 offen
    s_add_u32 s4, s4, 1024
    buffer_store_dwordx4 v[4:7], v2, s[48:51], s4 offen
    s_add_u32 s4, s4, 1024
    buffer_store_dwordx4 v[4:7], v2, s[48:51], s4 offen
    s_add_u32 s4, s4, 1024
    buffer_store_dwordx4 v[4:7], v2, s[48:51], s4 offen
    s_add_u32 s4, s4, 1024
    buffer_store_dwordx4 v[4:7], v2, s[48:51], s4 offen
    s_add_u32 s4, s4, 1024
    buffer_store_dwordx4 v[4:7], v2, s[48:51], s4 offen
    s_add_u32 s4, s4, 1024
    buffer_store_dwordx4 v[4:7], v2, s[48:51], s4 offen
    s_add_u32 s4, s4, 1024
    buffer_store_dwordx4 v[4:7], v2, s[48:51], s4 offen
    s_add_u32 s4, s4, 1024
    buffer_store_dwordx4 v[4:7], v2, s[48:51], s4 offen
    s_add_u32 s4, s4, 1024
    buffer_store_dwordx4 v[4:7], v2, s[48:51], s4 offen
    s_add_u32 s4, s4, 1024
    buffer_store_dwordx4 v[4:7], v2, s[48:51], s4 offen
    s_add_u32 s4, s4, 1024
    buffer_store_dwordx4 v[4:7], v2, s[48:51], s4 offen
    s_add_u32 s4, s4, 1024
    buffer_store_dwordx4 v[4:7], v2, s[48:51], s4 offen
    s_add_u32 s4, s4, 1024
    buffer_store_dwordx4 v[4:7], v2, s[48:51], s4 offen
    s_add_u32 s4, s4, 1024
    buffer_store_dwordx4 v[4:7], v2, s[48:51], s4 offen
    s_add_u32 s4, s4, 1024
    buffer_store_dwordx4 v[4:7], v2, s[48:51], s4 offen
    s_add_u32 s4, s4, 1024
    buffer_store_dwordx4 v[4:7], v2, s[48:51], s4 offen
    s_add_u32 s4, s4, 1024
    buffer_store_dwordx4 v[4:7], v2, s[48:51], s4 offen
    s_add_u32 s4, s4, 1024
    buffer_store_dwordx4 v[4:7], v2, s[48:51], s4 offen
    s_add_u32 s4, s4, 1024
    buffer_store_dwordx4 v[4:7], v2, s[48:51], s4 offen
    s_add_u32 s4, s4, 1024
    buffer_store_dwordx4 v[4:7], v2, s[48:51], s4 offen
    s_add_u32 s4, s4, 1024
    buffer_store_dwordx4 v[4:7], v2, s[48:51], s4 offen
    s_add_u32 s4, s4, 1024
    buffer_store_dwordx4 v[4:7], v2, s[48:51], s4 offen
    s_add_u32 s4, s4, 1024
    buffer_store_dwordx4 v[4:7], v2, s[48:51], s4 offen
    s_add_u32 s4, s4, 1024
    buffer_store_dwordx4 v[4:7], v2, s[48:51], s4 offen
    s_add_u32 s4, s4, 1024
    buffer_store_dwordx4 v[4:7], v2, s[48:51], s4 offen
    s_add_u32 s4, s4, 1024
    buffer_store_dwordx4 v[4:7], v2, s[48:51], s4 offen
    s_endpgm
K1_GATE:
    s_mov_b32 s52, s16
    s_and_b32 s53, s17, 0xffff
    s_mov_b32 s54, 2621440
    s_mov_b32 s55, 0x20000
    s_mul_i32 s5, s4, 40960
    v_and_b32 v2, 15, v0
    v_lshlrev_b32 v3, 4, v2
    global_load_dwordx4 v[8:11], v3, s[40:41] offset:0
    global_load_dwordx4 v[12:15], v3, s[40:41] offset:256
    global_load_dwordx4 v[16:19], v3, s[40:41] offset:512
    global_load_dwordx4 v[20:23], v3, s[40:41] offset:768
    global_load_dwordx4 v[24:27], v3, s[40:41] offset:1024
    v_lshrrev_b32 v4, 4, v0
    v_mul_u32_u24 v5, 1280, v4
    v_add_u32 v5, v5, v3
    v_mov_b32 v112, 0
    v_mov_b32 v113, 0
    v_mov_b32 v114, 0
    v_mov_b32 v115, 0
    v_mov_b32 v116, 0
    v_mov_b32 v117, 0
    v_mov_b32 v118, 0
    v_mov_b32 v119, 0
    buffer_load_dwordx4 v[32:35], v5, s[52:55], s5 offen offset:0
    buffer_load_dwordx4 v[36:39], v5, s[52:55], s5 offen offset:256
    buffer_load_dwordx4 v[40:43], v5, s[52:55], s5 offen offset:512
    buffer_load_dwordx4 v[44:47], v5, s[52:55], s5 offen offset:768
    buffer_load_dwordx4 v[48:51], v5, s[52:55], s5 offen offset:1024
    s_add_u32 s5, s5, 5120
    buffer_load_dwordx4 v[52:55], v5, s[52:55], s5 offen offset:0
    buffer_load_dwordx4 v[56:59], v5, s[52:55], s5 offen offset:256
    buffer_load_dwordx4 v[60:63], v5, s[52:55], s5 offen offset:512
    buffer_load_dwordx4 v[64:67], v5, s[52:55], s5 offen offset:768
    buffer_load_dwordx4 v[68:71], v5, s[52:55], s5 offen offset:1024
    s_add_u32 s5, s5, 5120
    buffer_load_dwordx4 v[72:75], v5, s[52:55], s5 offen offset:0
    buffer_load_dwordx4 v[76:79], v5, s[52:55], s5 offen offset:256
    buffer_load_dwordx4 v[80:83], v5, s[52:55], s5 offen offset:512
    buffer_load_dwordx4 v[84:87], v5, s[52:55], s5 offen offset:768
    buffer_load_dwordx4 v[88:91], v5, s[52:55], s5 offen offset:1024
    s_add_u32 s5, s5, 5120
    buffer_load_dwordx4 v[92:95], v5, s[52:55], s5 offen offset:0
    buffer_load_dwordx4 v[96:99], v5, s[52:55], s5 offen offset:256
    buffer_load_dwordx4 v[100:103], v5, s[52:55], s5 offen offset:512
    buffer_load_dwordx4 v[104:107], v5, s[52:55], s5 offen offset:768
    buffer_load_dwordx4 v[108:111], v5, s[52:55], s5 offen offset:1024
    s_add_u32 s5, s5, 5120
    s_waitcnt vmcnt(15)
    v_dot2c_f32_bf16 v112, v32, v8
    v_dot2c_f32_bf16 v112, v33, v9
    v_dot2c_f32_bf16 v112, v34, v10
    v_dot2c_f32_bf16 v112, v35, v11
    v_dot2c_f32_bf16 v112, v36, v12
    v_dot2c_f32_bf16 v112, v37, v13
    v_dot2c_f32_bf16 v112, v38, v14
    v_dot2c_f32_bf16 v112, v39, v15
    v_dot2c_f32_bf16 v112, v40, v16
    v_dot2c_f32_bf16 v112, v41, v17
    v_dot2c_f32_bf16 v112, v42, v18
    v_dot2c_f32_bf16 v112, v43, v19
    v_dot2c_f32_bf16 v112, v44, v20
    v_dot2c_f32_bf16 v112, v45, v21
    v_dot2c_f32_bf16 v112, v46, v22
    v_dot2c_f32_bf16 v112, v47, v23
    v_dot2c_f32_bf16 v112, v48, v24
    v_dot2c_f32_bf16 v112, v49, v25
    v_dot2c_f32_bf16 v112, v50, v26
    v_dot2c_f32_bf16 v112, v51, v27
    buffer_load_dwordx4 v[32:35], v5, s[52:55], s5 offen offset:0
    buffer_load_dwordx4 v[36:39], v5, s[52:55], s5 offen offset:256
    buffer_load_dwordx4 v[40:43], v5, s[52:55], s5 offen offset:512
    buffer_load_dwordx4 v[44:47], v5, s[52:55], s5 offen offset:768
    buffer_load_dwordx4 v[48:51], v5, s[52:55], s5 offen offset:1024
    s_add_u32 s5, s5, 5120
    s_waitcnt vmcnt(15)
    v_dot2c_f32_bf16 v113, v52, v8
    v_dot2c_f32_bf16 v113, v53, v9
    v_dot2c_f32_bf16 v113, v54, v10
    v_dot2c_f32_bf16 v113, v55, v11
    v_dot2c_f32_bf16 v113, v56, v12
    v_dot2c_f32_bf16 v113, v57, v13
    v_dot2c_f32_bf16 v113, v58, v14
    v_dot2c_f32_bf16 v113, v59, v15
    v_dot2c_f32_bf16 v113, v60, v16
    v_dot2c_f32_bf16 v113, v61, v17
    v_dot2c_f32_bf16 v113, v62, v18
    v_dot2c_f32_bf16 v113, v63, v19
    v_dot2c_f32_bf16 v113, v64, v20
    v_dot2c_f32_bf16 v113, v65, v21
    v_dot2c_f32_bf16 v113, v66, v22
    v_dot2c_f32_bf16 v113, v67, v23
    v_dot2c_f32_bf16 v113, v68, v24
    v_dot2c_f32_bf16 v113, v69, v25
    v_dot2c_f32_bf16 v113, v70, v26
    v_dot2c_f32_bf16 v113, v71, v27
    buffer_load_dwordx4 v[52:55], v5, s[52:55], s5 offen offset:0
    buffer_load_dwordx4 v[56:59], v5, s[52:55], s5 offen offset:256
    buffer_load_dwordx4 v[60:63], v5, s[52:55], s5 offen offset:512
    buffer_load_dwordx4 v[64:67], v5, s[52:55], s5 offen offset:768
    buffer_load_dwordx4 v[68:71], v5, s[52:55], s5 offen offset:1024
    s_add_u32 s5, s5, 5120
    s_waitcnt vmcnt(15)
    v_dot2c_f32_bf16 v114, v72, v8
    v_dot2c_f32_bf16 v114, v73, v9
    v_dot2c_f32_bf16 v114, v74, v10
    v_dot2c_f32_bf16 v114, v75, v11
    v_dot2c_f32_bf16 v114, v76, v12
    v_dot2c_f32_bf16 v114, v77, v13
    v_dot2c_f32_bf16 v114, v78, v14
    v_dot2c_f32_bf16 v114, v79, v15
    v_dot2c_f32_bf16 v114, v80, v16
    v_dot2c_f32_bf16 v114, v81, v17
    v_dot2c_f32_bf16 v114, v82, v18
    v_dot2c_f32_bf16 v114, v83, v19
    v_dot2c_f32_bf16 v114, v84, v20
    v_dot2c_f32_bf16 v114, v85, v21
    v_dot2c_f32_bf16 v114, v86, v22
    v_dot2c_f32_bf16 v114, v87, v23
    v_dot2c_f32_bf16 v114, v88, v24
    v_dot2c_f32_bf16 v114, v89, v25
    v_dot2c_f32_bf16 v114, v90, v26
    v_dot2c_f32_bf16 v114, v91, v27
    buffer_load_dwordx4 v[72:75], v5, s[52:55], s5 offen offset:0
    buffer_load_dwordx4 v[76:79], v5, s[52:55], s5 offen offset:256
    buffer_load_dwordx4 v[80:83], v5, s[52:55], s5 offen offset:512
    buffer_load_dwordx4 v[84:87], v5, s[52:55], s5 offen offset:768
    buffer_load_dwordx4 v[88:91], v5, s[52:55], s5 offen offset:1024
    s_add_u32 s5, s5, 5120
    s_waitcnt vmcnt(15)
    v_dot2c_f32_bf16 v115, v92, v8
    v_dot2c_f32_bf16 v115, v93, v9
    v_dot2c_f32_bf16 v115, v94, v10
    v_dot2c_f32_bf16 v115, v95, v11
    v_dot2c_f32_bf16 v115, v96, v12
    v_dot2c_f32_bf16 v115, v97, v13
    v_dot2c_f32_bf16 v115, v98, v14
    v_dot2c_f32_bf16 v115, v99, v15
    v_dot2c_f32_bf16 v115, v100, v16
    v_dot2c_f32_bf16 v115, v101, v17
    v_dot2c_f32_bf16 v115, v102, v18
    v_dot2c_f32_bf16 v115, v103, v19
    v_dot2c_f32_bf16 v115, v104, v20
    v_dot2c_f32_bf16 v115, v105, v21
    v_dot2c_f32_bf16 v115, v106, v22
    v_dot2c_f32_bf16 v115, v107, v23
    v_dot2c_f32_bf16 v115, v108, v24
    v_dot2c_f32_bf16 v115, v109, v25
    v_dot2c_f32_bf16 v115, v110, v26
    v_dot2c_f32_bf16 v115, v111, v27
    buffer_load_dwordx4 v[92:95], v5, s[52:55], s5 offen offset:0
    buffer_load_dwordx4 v[96:99], v5, s[52:55], s5 offen offset:256
    buffer_load_dwordx4 v[100:103], v5, s[52:55], s5 offen offset:512
    buffer_load_dwordx4 v[104:107], v5, s[52:55], s5 offen offset:768
    buffer_load_dwordx4 v[108:111], v5, s[52:55], s5 offen offset:1024
    s_waitcnt vmcnt(15)
    v_dot2c_f32_bf16 v116, v32, v8
    v_dot2c_f32_bf16 v116, v33, v9
    v_dot2c_f32_bf16 v116, v34, v10
    v_dot2c_f32_bf16 v116, v35, v11
    v_dot2c_f32_bf16 v116, v36, v12
    v_dot2c_f32_bf16 v116, v37, v13
    v_dot2c_f32_bf16 v116, v38, v14
    v_dot2c_f32_bf16 v116, v39, v15
    v_dot2c_f32_bf16 v116, v40, v16
    v_dot2c_f32_bf16 v116, v41, v17
    v_dot2c_f32_bf16 v116, v42, v18
    v_dot2c_f32_bf16 v116, v43, v19
    v_dot2c_f32_bf16 v116, v44, v20
    v_dot2c_f32_bf16 v116, v45, v21
    v_dot2c_f32_bf16 v116, v46, v22
    v_dot2c_f32_bf16 v116, v47, v23
    v_dot2c_f32_bf16 v116, v48, v24
    v_dot2c_f32_bf16 v116, v49, v25
    v_dot2c_f32_bf16 v116, v50, v26
    v_dot2c_f32_bf16 v116, v51, v27
    s_waitcnt vmcnt(10)
    v_dot2c_f32_bf16 v117, v52, v8
    v_dot2c_f32_bf16 v117, v53, v9
    v_dot2c_f32_bf16 v117, v54, v10
    v_dot2c_f32_bf16 v117, v55, v11
    v_dot2c_f32_bf16 v117, v56, v12
    v_dot2c_f32_bf16 v117, v57, v13
    v_dot2c_f32_bf16 v117, v58, v14
    v_dot2c_f32_bf16 v117, v59, v15
    v_dot2c_f32_bf16 v117, v60, v16
    v_dot2c_f32_bf16 v117, v61, v17
    v_dot2c_f32_bf16 v117, v62, v18
    v_dot2c_f32_bf16 v117, v63, v19
    v_dot2c_f32_bf16 v117, v64, v20
    v_dot2c_f32_bf16 v117, v65, v21
    v_dot2c_f32_bf16 v117, v66, v22
    v_dot2c_f32_bf16 v117, v67, v23
    v_dot2c_f32_bf16 v117, v68, v24
    v_dot2c_f32_bf16 v117, v69, v25
    v_dot2c_f32_bf16 v117, v70, v26
    v_dot2c_f32_bf16 v117, v71, v27
    s_waitcnt vmcnt(5)
    v_dot2c_f32_bf16 v118, v72, v8
    v_dot2c_f32_bf16 v118, v73, v9
    v_dot2c_f32_bf16 v118, v74, v10
    v_dot2c_f32_bf16 v118, v75, v11
    v_dot2c_f32_bf16 v118, v76, v12
    v_dot2c_f32_bf16 v118, v77, v13
    v_dot2c_f32_bf16 v118, v78, v14
    v_dot2c_f32_bf16 v118, v79, v15
    v_dot2c_f32_bf16 v118, v80, v16
    v_dot2c_f32_bf16 v118, v81, v17
    v_dot2c_f32_bf16 v118, v82, v18
    v_dot2c_f32_bf16 v118, v83, v19
    v_dot2c_f32_bf16 v118, v84, v20
    v_dot2c_f32_bf16 v118, v85, v21
    v_dot2c_f32_bf16 v118, v86, v22
    v_dot2c_f32_bf16 v118, v87, v23
    v_dot2c_f32_bf16 v118, v88, v24
    v_dot2c_f32_bf16 v118, v89, v25
    v_dot2c_f32_bf16 v118, v90, v26
    v_dot2c_f32_bf16 v118, v91, v27
    s_waitcnt vmcnt(0)
    v_dot2c_f32_bf16 v119, v92, v8
    v_dot2c_f32_bf16 v119, v93, v9
    v_dot2c_f32_bf16 v119, v94, v10
    v_dot2c_f32_bf16 v119, v95, v11
    v_dot2c_f32_bf16 v119, v96, v12
    v_dot2c_f32_bf16 v119, v97, v13
    v_dot2c_f32_bf16 v119, v98, v14
    v_dot2c_f32_bf16 v119, v99, v15
    v_dot2c_f32_bf16 v119, v100, v16
    v_dot2c_f32_bf16 v119, v101, v17
    v_dot2c_f32_bf16 v119, v102, v18
    v_dot2c_f32_bf16 v119, v103, v19
    v_dot2c_f32_bf16 v119, v104, v20
    v_dot2c_f32_bf16 v119, v105, v21
    v_dot2c_f32_bf16 v119, v106, v22
    v_dot2c_f32_bf16 v119, v107, v23
    v_dot2c_f32_bf16 v119, v108, v24
    v_dot2c_f32_bf16 v119, v109, v25
    v_dot2c_f32_bf16 v119, v110, v26
    v_dot2c_f32_bf16 v119, v111, v27
    v_add_f32_dpp v112, v112, v112 row_ror:8 row_mask:0xf bank_mask:0xf
    v_add_f32_dpp v113, v113, v113 row_ror:8 row_mask:0xf bank_mask:0xf
    v_add_f32_dpp v114, v114, v114 row_ror:8 row_mask:0xf bank_mask:0xf
    v_add_f32_dpp v115, v115, v115 row_ror:8 row_mask:0xf bank_mask:0xf
    v_add_f32_dpp v116, v116, v116 row_ror:8 row_mask:0xf bank_mask:0xf
    v_add_f32_dpp v117, v117, v117 row_ror:8 row_mask:0xf bank_mask:0xf
    v_add_f32_dpp v118, v118, v118 row_ror:8 row_mask:0xf bank_mask:0xf
    v_add_f32_dpp v119, v119, v119 row_ror:8 row_mask:0xf bank_mask:0xf
    v_add_f32_dpp v112, v112, v112 row_ror:4 row_mask:0xf bank_mask:0xf
    v_add_f32_dpp v113, v113, v113 row_ror:4 row_mask:0xf bank_mask:0xf
    v_add_f32_dpp v114, v114, v114 row_ror:4 row_mask:0xf bank_mask:0xf
    v_add_f32_dpp v115, v115, v115 row_ror:4 row_mask:0xf bank_mask:0xf
    v_add_f32_dpp v116, v116, v116 row_ror:4 row_mask:0xf bank_mask:0xf
    v_add_f32_dpp v117, v117, v117 row_ror:4 row_mask:0xf bank_mask:0xf
    v_add_f32_dpp v118, v118, v118 row_ror:4 row_mask:0xf bank_mask:0xf
    v_add_f32_dpp v119, v119, v119 row_ror:4 row_mask:0xf bank_mask:0xf
    v_add_f32_dpp v112, v112, v112 row_ror:2 row_mask:0xf bank_mask:0xf
    v_add_f32_dpp v113, v113, v113 row_ror:2 row_mask:0xf bank_mask:0xf
    v_add_f32_dpp v114, v114, v114 row_ror:2 row_mask:0xf bank_mask:0xf
    v_add_f32_dpp v115, v115, v115 row_ror:2 row_mask:0xf bank_mask:0xf
    v_add_f32_dpp v116, v116, v116 row_ror:2 row_mask:0xf bank_mask:0xf
    v_add_f32_dpp v117, v117, v117 row_ror:2 row_mask:0xf bank_mask:0xf
    v_add_f32_dpp v118, v118, v118 row_ror:2 row_mask:0xf bank_mask:0xf
    v_add_f32_dpp v119, v119, v119 row_ror:2 row_mask:0xf bank_mask:0xf
    v_add_f32_dpp v112, v112, v112 row_ror:1 row_mask:0xf bank_mask:0xf
    v_add_f32_dpp v113, v113, v113 row_ror:1 row_mask:0xf bank_mask:0xf
    v_add_f32_dpp v114, v114, v114 row_ror:1 row_mask:0xf bank_mask:0xf
    v_add_f32_dpp v115, v115, v115 row_ror:1 row_mask:0xf bank_mask:0xf
    v_add_f32_dpp v116, v116, v116 row_ror:1 row_mask:0xf bank_mask:0xf
    v_add_f32_dpp v117, v117, v117 row_ror:1 row_mask:0xf bank_mask:0xf
    v_add_f32_dpp v118, v118, v118 row_ror:1 row_mask:0xf bank_mask:0xf
    v_add_f32_dpp v119, v119, v119 row_ror:1 row_mask:0xf bank_mask:0xf
    v_cmp_eq_u32 vcc, 1, v2
    s_nop 1
    v_cndmask_b32 v112, v112, v113, vcc
    v_cmp_eq_u32 vcc, 2, v2
    s_nop 1
    v_cndmask_b32 v112, v112, v114, vcc
    v_cmp_eq_u32 vcc, 3, v2
    s_nop 1
    v_cndmask_b32 v112, v112, v115, vcc
    v_cmp_eq_u32 vcc, 4, v2
    s_nop 1
    v_cndmask_b32 v112, v112, v116, vcc
    v_cmp_eq_u32 vcc, 5, v2
    s_nop 1
    v_cndmask_b32 v112, v112, v117, vcc
    v_cmp_eq_u32 vcc, 6, v2
    s_nop 1
    v_cndmask_b32 v112, v112, v118, vcc
    v_cmp_eq_u32 vcc, 7, v2
    s_nop 1
    v_cndmask_b32 v112, v112, v119, vcc
    v_cvt_pk_bf16_f32 v112, v112, v112
    v_lshlrev_b32 v112, 16, v112
    v_mul_f32 v112, 3216550459, v112
    v_exp_f32 v112, v112
    s_nop 0
    v_add_f32 v112, 1.0, v112
    v_rcp_f32 v112, v112
    s_nop 0
    v_cvt_pk_bf16_f32 v112, v112, v112
    v_lshlrev_b32 v112, 16, v112
    v_lshl_add_u32 v5, v2, 2, v4
    v_lshlrev_b32 v5, 2, v5
    s_lshl_b32 s5, s4, 7
    s_add_u32 s5, s5, 20971520
    v_cmp_gt_u32 vcc, 8, v2
    s_nop 0
    s_and_saveexec_b64 s[6:7], vcc
    buffer_store_dword v112, v5, s[48:51], s5 offen
    s_endpgm
K1_KGEN:
    s_lshl_b32 s5, s4, 8
    v_lshl_add_u32 v2, v0, 2, s5
    global_load_dword v52, v2, s[24:25]
    global_load_dword v53, v2, s[26:27]
    global_load_dword v54, v2, s[28:29]
    global_load_dword v55, v2, s[30:31]
    global_load_dword v56, v2, s[32:33]
    global_load_dword v57, v2, s[34:35]
    s_lshl_b32 s6, s4, 1
    v_mov_b32 v3, s6
    global_load_ushort v58, v3, s[36:37]
    global_load_ushort v8, v3, s[38:39]
    s_mul_i32 s7, s3, 13312
    v_lshl_add_u32 v9, v0, 3, s7
    v_and_b32 v4, 15, v0
    v_lshrrev_b32 v5, 4, v0
    v_mul_u32_u24 v10, 528, v4
    v_lshl_add_u32 v10, v5, 4, v10
    v_add_u32 v10, s7, v10
    s_add_u32 s8, s7, 8448
    v_lshlrev_b32 v11, 4, v4
    v_lshl_add_u32 v11, v5, 2, v11
    v_lshl_add_u32 v11, v11, 2, s8
    v_lshlrev_b32 v6, 3, v4
    v_lshl_add_u32 v6, v5, 2, v6
    v_add_u32 v6, 256, v6
    v_lshlrev_b32 v7, 2, v4
    v_lshl_add_u32 v7, v5, 6, v7
    v_add_u32 v7, 256, v7
    v_cmp_gt_u32 vcc, 32, v0
    s_nop 1
    v_cndmask_b32 v12, v7, v6, vcc
    v_lshl_add_u32 v12, v12, 2, s8
    v_lshlrev_b32 v6, 1, v4
    v_lshl_add_u32 v6, v5, 6, v6
    v_add_u32 v6, 512, v6
    v_mov_b32 v7, 704
    v_cmp_ge_u32 vcc, 32, v0
    s_nop 1
    v_cndmask_b32 v13, v7, v6, vcc
    v_lshl_add_u32 v13, v13, 2, s8
    s_waitcnt vmcnt(0)
    v_lshlrev_b32 v2, 16, v58
    s_mov_b32 s9, 1069066811
    v_mul_f32 v3, s9, v2
    v_fma_f32 v4, v2, s9, -v3
    v_mov_b32 v5, 849703008
    v_fmac_f32 v4, v2, v5
    v_exp_f32 v3, v3
    v_mul_f32 v4, 1060205080, v4
    v_fma_f32 v3, v3, v4, v3
    v_cvt_pk_bf16_f32 v14, v3, v3
    v_lshlrev_b32 v14, 16, v14
    v_lshlrev_b32 v16, 16, v52
    v_lshlrev_b32 v17, 16, v53
    v_and_b32 v18, 0xffff0000, v52
    v_and_b32 v19, 0xffff0000, v53
    v_lshlrev_b32 v20, 16, v54
    v_lshlrev_b32 v21, 16, v55
    v_and_b32 v22, 0xffff0000, v54
    v_and_b32 v23, 0xffff0000, v55
    v_lshlrev_b32 v24, 16, v56
    v_lshlrev_b32 v25, 16, v57
    v_and_b32 v26, 0xffff0000, v56
    v_and_b32 v27, 0xffff0000, v57
    v_mul_f32 v16, v14, v16
    v_mul_f32 v20, v14, v20
    v_mul_f32 v17, v14, v17
    v_mul_f32 v21, v14, v21
    v_mul_f32 v18, v14, v18
    v_mul_f32 v22, v14, v22
    v_mul_f32 v19, v14, v19
    v_mul_f32 v23, v14, v23
    v_pk_mul_f32 v[28:29], v[24:25], v[20:21] op_sel:[0,0] op_sel_hi:[0,1]
    v_pk_mul_f32 v[30:31], v[26:27], v[22:23] op_sel:[0,0] op_sel_hi:[0,1]
    v_pk_fma_f32 v[28:29], v[24:25], v[20:21], v[28:29] op_sel:[1,1,0] op_sel_hi:[1,0,1] neg_lo:[0,1,0]
    v_pk_fma_f32 v[30:31], v[26:27], v[22:23], v[30:31] op_sel:[1,1,0] op_sel_hi:[1,0,1] neg_lo:[0,1,0]
    s_mov_b32 s10, 1042479491
    v_mul_f32 v16, s9, v16
    v_mul_f32 v17, s10, v17
    v_mul_f32 v18, s9, v18
    v_mul_f32 v19, s10, v19
    s_mov_b32 s11, 1098907648
    v_mul_f32 v44, s11, v16
    v_mul_f32 v45, s11, v17
    v_fract_f32 v45, v45
    v_exp_f32 v44, v44
    v_mul_f32 v46, s11, v18
    v_mul_f32 v47, s11, v19
    v_fract_f32 v47, v47
    v_exp_f32 v46, v46
    v_cos_f32 v36, v45
    v_sin_f32 v37, v45
    v_cos_f32 v38, v47
    v_sin_f32 v39, v47
    v_pk_mul_f32 v[36:37], v[36:37], v[44:45] op_sel:[0,0] op_sel_hi:[1,0]
    v_pk_mul_f32 v[38:39], v[38:39], v[46:47] op_sel:[0,0] op_sel_hi:[1,0]
    v_cvt_pk_bf16_f32 v2, v28, -v29
    v_cvt_pk_bf16_f32 v3, v30, -v31
    ds_write_b64 v9, v[2:3] offset:0
    v_pk_mul_f32 v[44:45], v[28:29], v[36:37] op_sel:[0,0] op_sel_hi:[0,1]
    v_pk_mul_f32 v[46:47], v[30:31], v[38:39] op_sel:[0,0] op_sel_hi:[0,1]
    v_pk_fma_f32 v[44:45], v[28:29], v[36:37], v[44:45] op_sel:[1,1,0] op_sel_hi:[1,0,1] neg_lo:[0,1,0]
    v_pk_fma_f32 v[46:47], v[30:31], v[38:39], v[46:47] op_sel:[1,1,0] op_sel_hi:[1,0,1] neg_lo:[0,1,0]
    v_cvt_pk_bf16_f32 v4, v44, -v45
    v_cvt_pk_bf16_f32 v5, v46, -v47
    ds_write_b64 v9, v[4:5] offset:528
    v_pk_mul_f32 v[48:49], v[44:45], v[36:37] op_sel:[0,0] op_sel_hi:[0,1]
    v_pk_mul_f32 v[50:51], v[46:47], v[38:39] op_sel:[0,0] op_sel_hi:[0,1]
    v_pk_fma_f32 v[48:49], v[44:45], v[36:37], v[48:49] op_sel:[1,1,0] op_sel_hi:[1,0,1] neg_lo:[0,1,0]
    v_pk_fma_f32 v[50:51], v[46:47], v[38:39], v[50:51] op_sel:[1,1,0] op_sel_hi:[1,0,1] neg_lo:[0,1,0]
    v_cvt_pk_bf16_f32 v2, v48, -v49
    v_cvt_pk_bf16_f32 v3, v50, -v51
    ds_write_b64 v9, v[2:3] offset:1056
    v_pk_mul_f32 v[44:45], v[48:49], v[36:37] op_sel:[0,0] op_sel_hi:[0,1]
    v_pk_mul_f32 v[46:47], v[50:51], v[38:39] op_sel:[0,0] op_sel_hi:[0,1]
    v_pk_fma_f32 v[44:45], v[48:49], v[36:37], v[44:45] op_sel:[1,1,0] op_sel_hi:[1,0,1] neg_lo:[0,1,0]
    v_pk_fma_f32 v[46:47], v[50:51], v[38:39], v[46:47] op_sel:[1,1,0] op_sel_hi:[1,0,1] neg_lo:[0,1,0]
    v_cvt_pk_bf16_f32 v4, v44, -v45
    v_cvt_pk_bf16_f32 v5, v46, -v47
    ds_write_b64 v9, v[4:5] offset:1584
    v_pk_mul_f32 v[48:49], v[44:45], v[36:37] op_sel:[0,0] op_sel_hi:[0,1]
    v_pk_mul_f32 v[50:51], v[46:47], v[38:39] op_sel:[0,0] op_sel_hi:[0,1]
    v_pk_fma_f32 v[48:49], v[44:45], v[36:37], v[48:49] op_sel:[1,1,0] op_sel_hi:[1,0,1] neg_lo:[0,1,0]
    v_pk_fma_f32 v[50:51], v[46:47], v[38:39], v[50:51] op_sel:[1,1,0] op_sel_hi:[1,0,1] neg_lo:[0,1,0]
    v_cvt_pk_bf16_f32 v2, v48, -v49
    v_cvt_pk_bf16_f32 v3, v50, -v51
    ds_write_b64 v9, v[2:3] offset:2112
    v_pk_mul_f32 v[44:45], v[48:49], v[36:37] op_sel:[0,0] op_sel_hi:[0,1]
    v_pk_mul_f32 v[46:47], v[50:51], v[38:39] op_sel:[0,0] op_sel_hi:[0,1]
    v_pk_fma_f32 v[44:45], v[48:49], v[36:37], v[44:45] op_sel:[1,1,0] op_sel_hi:[1,0,1] neg_lo:[0,1,0]
    v_pk_fma_f32 v[46:47], v[50:51], v[38:39], v[46:47] op_sel:[1,1,0] op_sel_hi:[1,0,1] neg_lo:[0,1,0]
    v_cvt_pk_bf16_f32 v4, v44, -v45
    v_cvt_pk_bf16_f32 v5, v46, -v47
    ds_write_b64 v9, v[4:5] offset:2640
    v_pk_mul_f32 v[48:49], v[44:45], v[36:37] op_sel:[0,0] op_sel_hi:[0,1]
    v_pk_mul_f32 v[50:51], v[46:47], v[38:39] op_sel:[0,0] op_sel_hi:[0,1]
    v_pk_fma_f32 v[48:49], v[44:45], v[36:37], v[48:49] op_sel:[1,1,0] op_sel_hi:[1,0,1] neg_lo:[0,1,0]
    v_pk_fma_f32 v[50:51], v[46:47], v[38:39], v[50:51] op_sel:[1,1,0] op_sel_hi:[1,0,1] neg_lo:[0,1,0]
    v_cvt_pk_bf16_f32 v2, v48, -v49
    v_cvt_pk_bf16_f32 v3, v50, -v51
    ds_write_b64 v9, v[2:3] offset:3168
    v_pk_mul_f32 v[44:45], v[48:49], v[36:37] op_sel:[0,0] op_sel_hi:[0,1]
    v_pk_mul_f32 v[46:47], v[50:51], v[38:39] op_sel:[0,0] op_sel_hi:[0,1]
    v_pk_fma_f32 v[44:45], v[48:49], v[36:37], v[44:45] op_sel:[1,1,0] op_sel_hi:[1,0,1] neg_lo:[0,1,0]
    v_pk_fma_f32 v[46:47], v[50:51], v[38:39], v[46:47] op_sel:[1,1,0] op_sel_hi:[1,0,1] neg_lo:[0,1,0]
    v_cvt_pk_bf16_f32 v4, v44, -v45
    v_cvt_pk_bf16_f32 v5, v46, -v47
    ds_write_b64 v9, v[4:5] offset:3696
    v_pk_mul_f32 v[48:49], v[44:45], v[36:37] op_sel:[0,0] op_sel_hi:[0,1]
    v_pk_mul_f32 v[50:51], v[46:47], v[38:39] op_sel:[0,0] op_sel_hi:[0,1]
    v_pk_fma_f32 v[48:49], v[44:45], v[36:37], v[48:49] op_sel:[1,1,0] op_sel_hi:[1,0,1] neg_lo:[0,1,0]
    v_pk_fma_f32 v[50:51], v[46:47], v[38:39], v[50:51] op_sel:[1,1,0] op_sel_hi:[1,0,1] neg_lo:[0,1,0]
    v_cvt_pk_bf16_f32 v2, v48, -v49
    v_cvt_pk_bf16_f32 v3, v50, -v51
    ds_write_b64 v9, v[2:3] offset:4224
    v_pk_mul_f32 v[44:45], v[48:49], v[36:37] op_sel:[0,0] op_sel_hi:[0,1]
    v_pk_mul_f32 v[46:47], v[50:51], v[38:39] op_sel:[0,0] op_sel_hi:[0,1]
    v_pk_fma_f32 v[44:45], v[48:49], v[36:37], v[44:45] op_sel:[1,1,0] op_sel_hi:[1,0,1] neg_lo:[0,1,0]
    v_pk_fma_f32 v[46:47], v[50:51], v[38:39], v[46:47] op_sel:[1,1,0] op_sel_hi:[1,0,1] neg_lo:[0,1,0]
    v_cvt_pk_bf16_f32 v4, v44, -v45
    v_cvt_pk_bf16_f32 v5, v46, -v47
    ds_write_b64 v9, v[4:5] offset:4752
    v_pk_mul_f32 v[48:49], v[44:45], v[36:37] op_sel:[0,0] op_sel_hi:[0,1]
    v_pk_mul_f32 v[50:51], v[46:47], v[38:39] op_sel:[0,0] op_sel_hi:[0,1]
    v_pk_fma_f32 v[48:49], v[44:45], v[36:37], v[48:49] op_sel:[1,1,0] op_sel_hi:[1,0,1] neg_lo:[0,1,0]
    v_pk_fma_f32 v[50:51], v[46:47], v[38:39], v[50:51] op_sel:[1,1,0] op_sel_hi:[1,0,1] neg_lo:[0,1,0]
    v_cvt_pk_bf16_f32 v2, v48, -v49
    v_cvt_pk_bf16_f32 v3, v50, -v51
    ds_write_b64 v9, v[2:3] offset:5280
    v_pk_mul_f32 v[44:45], v[48:49], v[36:37] op_sel:[0,0] op_sel_hi:[0,1]
    v_pk_mul_f32 v[46:47], v[50:51], v[38:39] op_sel:[0,0] op_sel_hi:[0,1]
    v_pk_fma_f32 v[44:45], v[48:49], v[36:37], v[44:45] op_sel:[1,1,0] op_sel_hi:[1,0,1] neg_lo:[0,1,0]
    v_pk_fma_f32 v[46:47], v[50:51], v[38:39], v[46:47] op_sel:[1,1,0] op_sel_hi:[1,0,1] neg_lo:[0,1,0]
    v_cvt_pk_bf16_f32 v4, v44, -v45
    v_cvt_pk_bf16_f32 v5, v46, -v47
    ds_write_b64 v9, v[4:5] offset:5808
    v_pk_mul_f32 v[48:49], v[44:45], v[36:37] op_sel:[0,0] op_sel_hi:[0,1]
    v_pk_mul_f32 v[50:51], v[46:47], v[38:39] op_sel:[0,0] op_sel_hi:[0,1]
    v_pk_fma_f32 v[48:49], v[44:45], v[36:37], v[48:49] op_sel:[1,1,0] op_sel_hi:[1,0,1] neg_lo:[0,1,0]
    v_pk_fma_f32 v[50:51], v[46:47], v[38:39], v[50:51] op_sel:[1,1,0] op_sel_hi:[1,0,1] neg_lo:[0,1,0]
    v_cvt_pk_bf16_f32 v2, v48, -v49
    v_cvt_pk_bf16_f32 v3, v50, -v51
    ds_write_b64 v9, v[2:3] offset:6336
    v_pk_mul_f32 v[44:45], v[48:49], v[36:37] op_sel:[0,0] op_sel_hi:[0,1]
    v_pk_mul_f32 v[46:47], v[50:51], v[38:39] op_sel:[0,0] op_sel_hi:[0,1]
    v_pk_fma_f32 v[44:45], v[48:49], v[36:37], v[44:45] op_sel:[1,1,0] op_sel_hi:[1,0,1] neg_lo:[0,1,0]
    v_pk_fma_f32 v[46:47], v[50:51], v[38:39], v[46:47] op_sel:[1,1,0] op_sel_hi:[1,0,1] neg_lo:[0,1,0]
    v_cvt_pk_bf16_f32 v4, v44, -v45
    v_cvt_pk_bf16_f32 v5, v46, -v47
    ds_write_b64 v9, v[4:5] offset:6864
    v_pk_mul_f32 v[48:49], v[44:45], v[36:37] op_sel:[0,0] op_sel_hi:[0,1]
    v_pk_mul_f32 v[50:51], v[46:47], v[38:39] op_sel:[0,0] op_sel_hi:[0,1]
    v_pk_fma_f32 v[48:49], v[44:45], v[36:37], v[48:49] op_sel:[1,1,0] op_sel_hi:[1,0,1] neg_lo:[0,1,0]
    v_pk_fma_f32 v[50:51], v[46:47], v[38:39], v[50:51] op_sel:[1,1,0] op_sel_hi:[1,0,1] neg_lo:[0,1,0]
    v_cvt_pk_bf16_f32 v2, v48, -v49
    v_cvt_pk_bf16_f32 v3, v50, -v51
    ds_write_b64 v9, v[2:3] offset:7392
    v_pk_mul_f32 v[44:45], v[48:49], v[36:37] op_sel:[0,0] op_sel_hi:[0,1]
    v_pk_mul_f32 v[46:47], v[50:51], v[38:39] op_sel:[0,0] op_sel_hi:[0,1]
    v_pk_fma_f32 v[44:45], v[48:49], v[36:37], v[44:45] op_sel:[1,1,0] op_sel_hi:[1,0,1] neg_lo:[0,1,0]
    v_pk_fma_f32 v[46:47], v[50:51], v[38:39], v[46:47] op_sel:[1,1,0] op_sel_hi:[1,0,1] neg_lo:[0,1,0]
    v_cvt_pk_bf16_f32 v4, v44, -v45
    v_cvt_pk_bf16_f32 v5, v46, -v47
    ds_write_b64 v9, v[4:5] offset:7920
    ds_read_b128 v[52:55], v10 offset:0
    ds_read_b128 v[56:59], v10 offset:64
    ds_read_b128 v[60:63], v10 offset:128
    ds_read_b128 v[64:67], v10 offset:192
    ds_read_b128 v[68:71], v10 offset:256
    ds_read_b128 v[72:75], v10 offset:320
    ds_read_b128 v[76:79], v10 offset:384
    ds_read_b128 v[80:83], v10 offset:448
    s_mov_b32 s11, 1065353216
    v_fract_f32 v45, v17
    v_exp_f32 v44, v16
    v_fract_f32 v47, v19
    v_exp_f32 v46, v18
    v_cos_f32 v32, v45
    v_sin_f32 v33, v45
    v_cos_f32 v34, v47
    v_sin_f32 v35, v47
    v_pk_mul_f32 v[32:33], v[32:33], v[44:45] op_sel:[0,0] op_sel_hi:[1,0]
    v_pk_mul_f32 v[34:35], v[34:35], v[46:47] op_sel:[0,0] op_sel_hi:[1,0]
    s_mov_b32 s11, 1132462080
    v_mul_f32 v44, s11, v16
    v_mul_f32 v45, s11, v17
    v_fract_f32 v45, v45
    v_exp_f32 v44, v44
    v_mul_f32 v46, s11, v18
    v_mul_f32 v47, s11, v19
    v_fract_f32 v47, v47
    v_exp_f32 v46, v46
    v_cos_f32 v40, v45
    v_sin_f32 v41, v45
    v_cos_f32 v42, v47
    v_sin_f32 v43, v47
    v_pk_mul_f32 v[40:41], v[40:41], v[44:45] op_sel:[0,0] op_sel_hi:[1,0]
    v_pk_mul_f32 v[42:43], v[42:43], v[46:47] op_sel:[0,0] op_sel_hi:[1,0]
    v_mov_b32 v6, 0x3f80
    v_mov_b32 v7, 0x3f80
    ds_write_b64 v9, v[6:7] offset:0
    v_cvt_pk_bf16_f32 v2, v32, v33
    v_cvt_pk_bf16_f32 v3, v34, v35
    ds_write_b64 v9, v[2:3] offset:528
    v_pk_mul_f32 v[84:85], v[32:33], v[32:33] op_sel:[0,0] op_sel_hi:[0,1]
    v_pk_mul_f32 v[86:87], v[34:35], v[34:35] op_sel:[0,0] op_sel_hi:[0,1]
    v_pk_fma_f32 v[84:85], v[32:33], v[32:33], v[84:85] op_sel:[1,1,0] op_sel_hi:[1,0,1] neg_lo:[0,1,0]
    v_pk_fma_f32 v[86:87], v[34:35], v[34:35], v[86:87] op_sel:[1,1,0] op_sel_hi:[1,0,1] neg_lo:[0,1,0]
    v_cvt_pk_bf16_f32 v4, v84, v85
    v_cvt_pk_bf16_f32 v5, v86, v87
    ds_write_b64 v9, v[4:5] offset:1056
    v_pk_mul_f32 v[44:45], v[84:85], v[32:33] op_sel:[0,0] op_sel_hi:[0,1]
    v_pk_mul_f32 v[46:47], v[86:87], v[34:35] op_sel:[0,0] op_sel_hi:[0,1]
    v_pk_fma_f32 v[44:45], v[84:85], v[32:33], v[44:45] op_sel:[1,1,0] op_sel_hi:[1,0,1] neg_lo:[0,1,0]
    v_pk_fma_f32 v[46:47], v[86:87], v[34:35], v[46:47] op_sel:[1,1,0] op_sel_hi:[1,0,1] neg_lo:[0,1,0]
    v_cvt_pk_bf16_f32 v2, v44, v45
    v_cvt_pk_bf16_f32 v3, v46, v47
    ds_write_b64 v9, v[2:3] offset:1584
    v_pk_mul_f32 v[88:89], v[44:45], v[32:33] op_sel:[0,0] op_sel_hi:[0,1]
    v_pk_mul_f32 v[90:91], v[46:47], v[34:35] op_sel:[0,0] op_sel_hi:[0,1]
    v_pk_fma_f32 v[88:89], v[44:45], v[32:33], v[88:89] op_sel:[1,1,0] op_sel_hi:[1,0,1] neg_lo:[0,1,0]
    v_pk_fma_f32 v[90:91], v[46:47], v[34:35], v[90:91] op_sel:[1,1,0] op_sel_hi:[1,0,1] neg_lo:[0,1,0]
    v_cvt_pk_bf16_f32 v4, v88, v89
    v_cvt_pk_bf16_f32 v5, v90, v91
    ds_write_b64 v9, v[4:5] offset:2112
    v_pk_mul_f32 v[44:45], v[88:89], v[32:33] op_sel:[0,0] op_sel_hi:[0,1]
    v_pk_mul_f32 v[46:47], v[90:91], v[34:35] op_sel:[0,0] op_sel_hi:[0,1]
    v_pk_fma_f32 v[44:45], v[88:89], v[32:33], v[44:45] op_sel:[1,1,0] op_sel_hi:[1,0,1] neg_lo:[0,1,0]
    v_pk_fma_f32 v[46:47], v[90:91], v[34:35], v[46:47] op_sel:[1,1,0] op_sel_hi:[1,0,1] neg_lo:[0,1,0]
    v_cvt_pk_bf16_f32 v2, v44, v45
    v_cvt_pk_bf16_f32 v3, v46, v47
    ds_write_b64 v9, v[2:3] offset:2640
    v_pk_mul_f32 v[92:93], v[44:45], v[32:33] op_sel:[0,0] op_sel_hi:[0,1]
    v_pk_mul_f32 v[94:95], v[46:47], v[34:35] op_sel:[0,0] op_sel_hi:[0,1]
    v_pk_fma_f32 v[92:93], v[44:45], v[32:33], v[92:93] op_sel:[1,1,0] op_sel_hi:[1,0,1] neg_lo:[0,1,0]
    v_pk_fma_f32 v[94:95], v[46:47], v[34:35], v[94:95] op_sel:[1,1,0] op_sel_hi:[1,0,1] neg_lo:[0,1,0]
    v_cvt_pk_bf16_f32 v4, v92, v93
    v_cvt_pk_bf16_f32 v5, v94, v95
    ds_write_b64 v9, v[4:5] offset:3168
    v_pk_mul_f32 v[44:45], v[92:93], v[32:33] op_sel:[0,0] op_sel_hi:[0,1]
    v_pk_mul_f32 v[46:47], v[94:95], v[34:35] op_sel:[0,0] op_sel_hi:[0,1]
    v_pk_fma_f32 v[44:45], v[92:93], v[32:33], v[44:45] op_sel:[1,1,0] op_sel_hi:[1,0,1] neg_lo:[0,1,0]
    v_pk_fma_f32 v[46:47], v[94:95], v[34:35], v[46:47] op_sel:[1,1,0] op_sel_hi:[1,0,1] neg_lo:[0,1,0]
    v_cvt_pk_bf16_f32 v2, v44, v45
    v_cvt_pk_bf16_f32 v3, v46, v47
    ds_write_b64 v9, v[2:3] offset:3696
    v_pk_mul_f32 v[96:97], v[44:45], v[32:33] op_sel:[0,0] op_sel_hi:[0,1]
    v_pk_mul_f32 v[98:99], v[46:47], v[34:35] op_sel:[0,0] op_sel_hi:[0,1]
    v_pk_fma_f32 v[96:97], v[44:45], v[32:33], v[96:97] op_sel:[1,1,0] op_sel_hi:[1,0,1] neg_lo:[0,1,0]
    v_pk_fma_f32 v[98:99], v[46:47], v[34:35], v[98:99] op_sel:[1,1,0] op_sel_hi:[1,0,1] neg_lo:[0,1,0]
    v_cvt_pk_bf16_f32 v4, v96, v97
    v_cvt_pk_bf16_f32 v5, v98, v99
    ds_write_b64 v9, v[4:5] offset:4224
    v_pk_mul_f32 v[44:45], v[96:97], v[32:33] op_sel:[0,0] op_sel_hi:[0,1]
    v_pk_mul_f32 v[46:47], v[98:99], v[34:35] op_sel:[0,0] op_sel_hi:[0,1]
    v_pk_fma_f32 v[44:45], v[96:97], v[32:33], v[44:45] op_sel:[1,1,0] op_sel_hi:[1,0,1] neg_lo:[0,1,0]
    v_pk_fma_f32 v[46:47], v[98:99], v[34:35], v[46:47] op_sel:[1,1,0] op_sel_hi:[1,0,1] neg_lo:[0,1,0]
    v_cvt_pk_bf16_f32 v2, v44, v45
    v_cvt_pk_bf16_f32 v3, v46, v47
    ds_write_b64 v9, v[2:3] offset:4752
    v_pk_mul_f32 v[100:101], v[44:45], v[32:33] op_sel:[0,0] op_sel_hi:[0,1]
    v_pk_mul_f32 v[102:103], v[46:47], v[34:35] op_sel:[0,0] op_sel_hi:[0,1]
    v_pk_fma_f32 v[100:101], v[44:45], v[32:33], v[100:101] op_sel:[1,1,0] op_sel_hi:[1,0,1] neg_lo:[0,1,0]
    v_pk_fma_f32 v[102:103], v[46:47], v[34:35], v[102:103] op_sel:[1,1,0] op_sel_hi:[1,0,1] neg_lo:[0,1,0]
    v_cvt_pk_bf16_f32 v4, v100, v101
    v_cvt_pk_bf16_f32 v5, v102, v103
    ds_write_b64 v9, v[4:5] offset:5280
    v_pk_mul_f32 v[44:45], v[100:101], v[32:33] op_sel:[0,0] op_sel_hi:[0,1]
    v_pk_mul_f32 v[46:47], v[102:103], v[34:35] op_sel:[0,0] op_sel_hi:[0,1]
    v_pk_fma_f32 v[44:45], v[100:101], v[32:33], v[44:45] op_sel:[1,1,0] op_sel_hi:[1,0,1] neg_lo:[0,1,0]
    v_pk_fma_f32 v[46:47], v[102:103], v[34:35], v[46:47] op_sel:[1,1,0] op_sel_hi:[1,0,1] neg_lo:[0,1,0]
    v_cvt_pk_bf16_f32 v2, v44, v45
    v_cvt_pk_bf16_f32 v3, v46, v47
    ds_write_b64 v9, v[2:3] offset:5808
    v_pk_mul_f32 v[104:105], v[44:45], v[32:33] op_sel:[0,0] op_sel_hi:[0,1]
    v_pk_mul_f32 v[106:107], v[46:47], v[34:35] op_sel:[0,0] op_sel_hi:[0,1]
    v_pk_fma_f32 v[104:105], v[44:45], v[32:33], v[104:105] op_sel:[1,1,0] op_sel_hi:[1,0,1] neg_lo:[0,1,0]
    v_pk_fma_f32 v[106:107], v[46:47], v[34:35], v[106:107] op_sel:[1,1,0] op_sel_hi:[1,0,1] neg_lo:[0,1,0]
    v_cvt_pk_bf16_f32 v4, v104, v105
    v_cvt_pk_bf16_f32 v5, v106, v107
    ds_write_b64 v9, v[4:5] offset:6336
    v_pk_mul_f32 v[44:45], v[104:105], v[32:33] op_sel:[0,0] op_sel_hi:[0,1]
    v_pk_mul_f32 v[46:47], v[106:107], v[34:35] op_sel:[0,0] op_sel_hi:[0,1]
    v_pk_fma_f32 v[44:45], v[104:105], v[32:33], v[44:45] op_sel:[1,1,0] op_sel_hi:[1,0,1] neg_lo:[0,1,0]
    v_pk_fma_f32 v[46:47], v[106:107], v[34:35], v[46:47] op_sel:[1,1,0] op_sel_hi:[1,0,1] neg_lo:[0,1,0]
    v_cvt_pk_bf16_f32 v2, v44, v45
    v_cvt_pk_bf16_f32 v3, v46, v47
    ds_write_b64 v9, v[2:3] offset:6864
    v_pk_mul_f32 v[108:109], v[44:45], v[32:33] op_sel:[0,0] op_sel_hi:[0,1]
    v_pk_mul_f32 v[110:111], v[46:47], v[34:35] op_sel:[0,0] op_sel_hi:[0,1]
    v_pk_fma_f32 v[108:109], v[44:45], v[32:33], v[108:109] op_sel:[1,1,0] op_sel_hi:[1,0,1] neg_lo:[0,1,0]
    v_pk_fma_f32 v[110:111], v[46:47], v[34:35], v[110:111] op_sel:[1,1,0] op_sel_hi:[1,0,1] neg_lo:[0,1,0]
    v_cvt_pk_bf16_f32 v4, v108, v109
    v_cvt_pk_bf16_f32 v5, v110, v111
    ds_write_b64 v9, v[4:5] offset:7392
    v_pk_mul_f32 v[44:45], v[108:109], v[32:33] op_sel:[0,0] op_sel_hi:[0,1]
    v_pk_mul_f32 v[46:47], v[110:111], v[34:35] op_sel:[0,0] op_sel_hi:[0,1]
    v_pk_fma_f32 v[44:45], v[108:109], v[32:33], v[44:45] op_sel:[1,1,0] op_sel_hi:[1,0,1] neg_lo:[0,1,0]
    v_pk_fma_f32 v[46:47], v[110:111], v[34:35], v[46:47] op_sel:[1,1,0] op_sel_hi:[1,0,1] neg_lo:[0,1,0]
    v_cvt_pk_bf16_f32 v2, v44, v45
    v_cvt_pk_bf16_f32 v3, v46, v47
    ds_write_b64 v9, v[2:3] offset:7920
    ds_read_b128 v[112:115], v10 offset:0
    ds_read_b128 v[116:119], v10 offset:64
    ds_read_b128 v[120:123], v10 offset:128
    ds_read_b128 v[124:127], v10 offset:192
    v_pk_mul_f32 v[32:33], v[40:41], v[40:41] op_sel:[0,0] op_sel_hi:[0,1]
    v_pk_mul_f32 v[34:35], v[42:43], v[42:43] op_sel:[0,0] op_sel_hi:[0,1]
    v_pk_fma_f32 v[32:33], v[40:41], v[40:41], v[32:33] op_sel:[1,1,0] op_sel_hi:[1,0,1] neg_lo:[0,1,0]
    v_pk_fma_f32 v[34:35], v[42:43], v[42:43], v[34:35] op_sel:[1,1,0] op_sel_hi:[1,0,1] neg_lo:[0,1,0]
    v_pk_mul_f32 v[36:37], v[32:33], v[40:41] op_sel:[0,0] op_sel_hi:[0,1]
    v_pk_mul_f32 v[38:39], v[34:35], v[42:43] op_sel:[0,0] op_sel_hi:[0,1]
    v_pk_fma_f32 v[36:37], v[32:33], v[40:41], v[36:37] op_sel:[1,1,0] op_sel_hi:[1,0,1] neg_lo:[0,1,0]
    v_pk_fma_f32 v[38:39], v[34:35], v[42:43], v[38:39] op_sel:[1,1,0] op_sel_hi:[1,0,1] neg_lo:[0,1,0]
    s_waitcnt lgkmcnt(3)
    v_mfma_f32_16x16x32_bf16 v[16:19], v[112:115], v[52:55], 0
    s_waitcnt lgkmcnt(2)
    v_mfma_f32_16x16x32_bf16 v[16:19], v[116:119], v[56:59], v[16:19]
    s_waitcnt lgkmcnt(1)
    v_mfma_f32_16x16x32_bf16 v[16:19], v[120:123], v[60:63], v[16:19]
    s_waitcnt lgkmcnt(0)
    v_mfma_f32_16x16x32_bf16 v[16:19], v[124:127], v[64:67], v[16:19]
    ds_read_b128 v[112:115], v10 offset:256
    ds_read_b128 v[116:119], v10 offset:320
    ds_read_b128 v[120:123], v10 offset:384
    ds_read_b128 v[124:127], v10 offset:448
    s_waitcnt lgkmcnt(3)
    v_mfma_f32_16x16x32_bf16 v[16:19], v[112:115], v[68:71], v[16:19]
    s_waitcnt lgkmcnt(2)
    v_mfma_f32_16x16x32_bf16 v[16:19], v[116:119], v[72:75], v[16:19]
    s_waitcnt lgkmcnt(1)
    v_mfma_f32_16x16x32_bf16 v[16:19], v[120:123], v[76:79], v[16:19]
    s_waitcnt lgkmcnt(0)
    v_mfma_f32_16x16x32_bf16 v[16:19], v[124:127], v[80:83], v[16:19]
    v_cvt_pk_bf16_f32 v4, v40, v41
    v_cvt_pk_bf16_f32 v5, v42, v43
    ds_write_b64 v9, v[4:5] offset:0
    v_pk_mul_f32 v[44:45], v[40:41], v[84:85] op_sel:[0,0] op_sel_hi:[0,1]
    v_pk_mul_f32 v[46:47], v[42:43], v[86:87] op_sel:[0,0] op_sel_hi:[0,1]
    v_pk_fma_f32 v[44:45], v[40:41], v[84:85], v[44:45] op_sel:[1,1,0] op_sel_hi:[1,0,1] neg_lo:[0,1,0]
    v_pk_fma_f32 v[46:47], v[42:43], v[86:87], v[46:47] op_sel:[1,1,0] op_sel_hi:[1,0,1] neg_lo:[0,1,0]
    v_cvt_pk_bf16_f32 v2, v44, v45
    v_cvt_pk_bf16_f32 v3, v46, v47
    ds_write_b64 v9, v[2:3] offset:528
    v_pk_mul_f32 v[44:45], v[40:41], v[88:89] op_sel:[0,0] op_sel_hi:[0,1]
    v_pk_mul_f32 v[46:47], v[42:43], v[90:91] op_sel:[0,0] op_sel_hi:[0,1]
    v_pk_fma_f32 v[44:45], v[40:41], v[88:89], v[44:45] op_sel:[1,1,0] op_sel_hi:[1,0,1] neg_lo:[0,1,0]
    v_pk_fma_f32 v[46:47], v[42:43], v[90:91], v[46:47] op_sel:[1,1,0] op_sel_hi:[1,0,1] neg_lo:[0,1,0]
    v_cvt_pk_bf16_f32 v4, v44, v45
    v_cvt_pk_bf16_f32 v5, v46, v47
    ds_write_b64 v9, v[4:5] offset:1056
    v_pk_mul_f32 v[44:45], v[40:41], v[92:93] op_sel:[0,0] op_sel_hi:[0,1]
    v_pk_mul_f32 v[46:47], v[42:43], v[94:95] op_sel:[0,0] op_sel_hi:[0,1]
    v_pk_fma_f32 v[44:45], v[40:41], v[92:93], v[44:45] op_sel:[1,1,0] op_sel_hi:[1,0,1] neg_lo:[0,1,0]
    v_pk_fma_f32 v[46:47], v[42:43], v[94:95], v[46:47] op_sel:[1,1,0] op_sel_hi:[1,0,1] neg_lo:[0,1,0]
    v_cvt_pk_bf16_f32 v2, v44, v45
    v_cvt_pk_bf16_f32 v3, v46, v47
    ds_write_b64 v9, v[2:3] offset:1584
    v_pk_mul_f32 v[44:45], v[40:41], v[96:97] op_sel:[0,0] op_sel_hi:[0,1]
    v_pk_mul_f32 v[46:47], v[42:43], v[98:99] op_sel:[0,0] op_sel_hi:[0,1]
    v_pk_fma_f32 v[44:45], v[40:41], v[96:97], v[44:45] op_sel:[1,1,0] op_sel_hi:[1,0,1] neg_lo:[0,1,0]
    v_pk_fma_f32 v[46:47], v[42:43], v[98:99], v[46:47] op_sel:[1,1,0] op_sel_hi:[1,0,1] neg_lo:[0,1,0]
    v_cvt_pk_bf16_f32 v4, v44, v45
    v_cvt_pk_bf16_f32 v5, v46, v47
    ds_write_b64 v9, v[4:5] offset:2112
    v_pk_mul_f32 v[44:45], v[40:41], v[100:101] op_sel:[0,0] op_sel_hi:[0,1]
    v_pk_mul_f32 v[46:47], v[42:43], v[102:103] op_sel:[0,0] op_sel_hi:[0,1]
    v_pk_fma_f32 v[44:45], v[40:41], v[100:101], v[44:45] op_sel:[1,1,0] op_sel_hi:[1,0,1] neg_lo:[0,1,0]
    v_pk_fma_f32 v[46:47], v[42:43], v[102:103], v[46:47] op_sel:[1,1,0] op_sel_hi:[1,0,1] neg_lo:[0,1,0]
    v_cvt_pk_bf16_f32 v2, v44, v45
    v_cvt_pk_bf16_f32 v3, v46, v47
    ds_write_b64 v9, v[2:3] offset:2640
    v_pk_mul_f32 v[44:45], v[40:41], v[104:105] op_sel:[0,0] op_sel_hi:[0,1]
    v_pk_mul_f32 v[46:47], v[42:43], v[106:107] op_sel:[0,0] op_sel_hi:[0,1]
    v_pk_fma_f32 v[44:45], v[40:41], v[104:105], v[44:45] op_sel:[1,1,0] op_sel_hi:[1,0,1] neg_lo:[0,1,0]
    v_pk_fma_f32 v[46:47], v[42:43], v[106:107], v[46:47] op_sel:[1,1,0] op_sel_hi:[1,0,1] neg_lo:[0,1,0]
    v_cvt_pk_bf16_f32 v4, v44, v45
    v_cvt_pk_bf16_f32 v5, v46, v47
    ds_write_b64 v9, v[4:5] offset:3168
    v_pk_mul_f32 v[44:45], v[40:41], v[108:109] op_sel:[0,0] op_sel_hi:[0,1]
    v_pk_mul_f32 v[46:47], v[42:43], v[110:111] op_sel:[0,0] op_sel_hi:[0,1]
    v_pk_fma_f32 v[44:45], v[40:41], v[108:109], v[44:45] op_sel:[1,1,0] op_sel_hi:[1,0,1] neg_lo:[0,1,0]
    v_pk_fma_f32 v[46:47], v[42:43], v[110:111], v[46:47] op_sel:[1,1,0] op_sel_hi:[1,0,1] neg_lo:[0,1,0]
    v_cvt_pk_bf16_f32 v2, v44, v45
    v_cvt_pk_bf16_f32 v3, v46, v47
    ds_write_b64 v9, v[2:3] offset:3696
    v_cvt_pk_bf16_f32 v4, v32, v33
    v_cvt_pk_bf16_f32 v5, v34, v35
    ds_write_b64 v9, v[4:5] offset:4224
    v_pk_mul_f32 v[44:45], v[32:33], v[88:89] op_sel:[0,0] op_sel_hi:[0,1]
    v_pk_mul_f32 v[46:47], v[34:35], v[90:91] op_sel:[0,0] op_sel_hi:[0,1]
    v_pk_fma_f32 v[44:45], v[32:33], v[88:89], v[44:45] op_sel:[1,1,0] op_sel_hi:[1,0,1] neg_lo:[0,1,0]
    v_pk_fma_f32 v[46:47], v[34:35], v[90:91], v[46:47] op_sel:[1,1,0] op_sel_hi:[1,0,1] neg_lo:[0,1,0]
    v_cvt_pk_bf16_f32 v2, v44, v45
    v_cvt_pk_bf16_f32 v3, v46, v47
    ds_write_b64 v9, v[2:3] offset:4752
    v_pk_mul_f32 v[44:45], v[32:33], v[96:97] op_sel:[0,0] op_sel_hi:[0,1]
    v_pk_mul_f32 v[46:47], v[34:35], v[98:99] op_sel:[0,0] op_sel_hi:[0,1]
    v_pk_fma_f32 v[44:45], v[32:33], v[96:97], v[44:45] op_sel:[1,1,0] op_sel_hi:[1,0,1] neg_lo:[0,1,0]
    v_pk_fma_f32 v[46:47], v[34:35], v[98:99], v[46:47] op_sel:[1,1,0] op_sel_hi:[1,0,1] neg_lo:[0,1,0]
    v_cvt_pk_bf16_f32 v4, v44, v45
    v_cvt_pk_bf16_f32 v5, v46, v47
    ds_write_b64 v9, v[4:5] offset:5280
    v_pk_mul_f32 v[44:45], v[32:33], v[104:105] op_sel:[0,0] op_sel_hi:[0,1]
    v_pk_mul_f32 v[46:47], v[34:35], v[106:107] op_sel:[0,0] op_sel_hi:[0,1]
    v_pk_fma_f32 v[44:45], v[32:33], v[104:105], v[44:45] op_sel:[1,1,0] op_sel_hi:[1,0,1] neg_lo:[0,1,0]
    v_pk_fma_f32 v[46:47], v[34:35], v[106:107], v[46:47] op_sel:[1,1,0] op_sel_hi:[1,0,1] neg_lo:[0,1,0]
    v_cvt_pk_bf16_f32 v2, v44, v45
    v_cvt_pk_bf16_f32 v3, v46, v47
    ds_write_b64 v9, v[2:3] offset:5808
    v_cvt_pk_bf16_f32 v4, v36, v37
    v_cvt_pk_bf16_f32 v5, v38, v39
    ds_write_b64 v9, v[4:5] offset:6336
    v_pk_mul_f32 v[44:45], v[36:37], v[88:89] op_sel:[0,0] op_sel_hi:[0,1]
    v_pk_mul_f32 v[46:47], v[38:39], v[90:91] op_sel:[0,0] op_sel_hi:[0,1]
    v_pk_fma_f32 v[44:45], v[36:37], v[88:89], v[44:45] op_sel:[1,1,0] op_sel_hi:[1,0,1] neg_lo:[0,1,0]
    v_pk_fma_f32 v[46:47], v[38:39], v[90:91], v[46:47] op_sel:[1,1,0] op_sel_hi:[1,0,1] neg_lo:[0,1,0]
    v_cvt_pk_bf16_f32 v2, v44, v45
    v_cvt_pk_bf16_f32 v3, v46, v47
    ds_write_b64 v9, v[2:3] offset:6864
    v_pk_mul_f32 v[44:45], v[36:37], v[96:97] op_sel:[0,0] op_sel_hi:[0,1]
    v_pk_mul_f32 v[46:47], v[38:39], v[98:99] op_sel:[0,0] op_sel_hi:[0,1]
    v_pk_fma_f32 v[44:45], v[36:37], v[96:97], v[44:45] op_sel:[1,1,0] op_sel_hi:[1,0,1] neg_lo:[0,1,0]
    v_pk_fma_f32 v[46:47], v[38:39], v[98:99], v[46:47] op_sel:[1,1,0] op_sel_hi:[1,0,1] neg_lo:[0,1,0]
    v_cvt_pk_bf16_f32 v4, v44, v45
    v_cvt_pk_bf16_f32 v5, v46, v47
    ds_write_b64 v9, v[4:5] offset:7392
    v_pk_mul_f32 v[44:45], v[36:37], v[104:105] op_sel:[0,0] op_sel_hi:[0,1]
    v_pk_mul_f32 v[46:47], v[38:39], v[106:107] op_sel:[0,0] op_sel_hi:[0,1]
    v_pk_fma_f32 v[44:45], v[36:37], v[104:105], v[44:45] op_sel:[1,1,0] op_sel_hi:[1,0,1] neg_lo:[0,1,0]
    v_pk_fma_f32 v[46:47], v[38:39], v[106:107], v[46:47] op_sel:[1,1,0] op_sel_hi:[1,0,1] neg_lo:[0,1,0]
    v_cvt_pk_bf16_f32 v2, v44, v45
    v_cvt_pk_bf16_f32 v3, v46, v47
    ds_write_b64 v9, v[2:3] offset:7920
    ds_read_b128 v[112:115], v10 offset:0
    ds_read_b128 v[116:119], v10 offset:64
    ds_read_b128 v[120:123], v10 offset:128
    ds_read_b128 v[124:127], v10 offset:192
    v_pk_mul_f32 v[48:49], v[32:33], v[32:33] op_sel:[0,0] op_sel_hi:[0,1]
    v_pk_mul_f32 v[50:51], v[34:35], v[34:35] op_sel:[0,0] op_sel_hi:[0,1]
    v_pk_fma_f32 v[48:49], v[32:33], v[32:33], v[48:49] op_sel:[1,1,0] op_sel_hi:[1,0,1] neg_lo:[0,1,0]
    v_pk_fma_f32 v[50:51], v[34:35], v[34:35], v[50:51] op_sel:[1,1,0] op_sel_hi:[1,0,1] neg_lo:[0,1,0]
    s_waitcnt lgkmcnt(3)
    v_mfma_f32_16x16x32_bf16 v[20:23], v[112:115], v[52:55], 0
    s_waitcnt lgkmcnt(2)
    v_mfma_f32_16x16x32_bf16 v[20:23], v[116:119], v[56:59], v[20:23]
    s_waitcnt lgkmcnt(1)
    v_mfma_f32_16x16x32_bf16 v[20:23], v[120:123], v[60:63], v[20:23]
    s_waitcnt lgkmcnt(0)
    v_mfma_f32_16x16x32_bf16 v[20:23], v[124:127], v[64:67], v[20:23]
    ds_read_b128 v[112:115], v10 offset:256
    ds_read_b128 v[116:119], v10 offset:320
    ds_read_b128 v[120:123], v10 offset:384
    ds_read_b128 v[124:127], v10 offset:448
    s_waitcnt lgkmcnt(3)
    v_mfma_f32_16x16x32_bf16 v[20:23], v[112:115], v[68:71], v[20:23]
    s_waitcnt lgkmcnt(2)
    v_mfma_f32_16x16x32_bf16 v[20:23], v[116:119], v[72:75], v[20:23]
    s_waitcnt lgkmcnt(1)
    v_mfma_f32_16x16x32_bf16 v[20:23], v[120:123], v[76:79], v[20:23]
    s_waitcnt lgkmcnt(0)
    v_mfma_f32_16x16x32_bf16 v[20:23], v[124:127], v[80:83], v[20:23]
    v_cvt_pk_bf16_f32 v4, v48, v49
    v_cvt_pk_bf16_f32 v5, v50, v51
    ds_write_b64 v9, v[4:5] offset:0
    v_pk_mul_f32 v[44:45], v[48:49], v[96:97] op_sel:[0,0] op_sel_hi:[0,1]
    v_pk_mul_f32 v[46:47], v[50:51], v[98:99] op_sel:[0,0] op_sel_hi:[0,1]
    v_pk_fma_f32 v[44:45], v[48:49], v[96:97], v[44:45] op_sel:[1,1,0] op_sel_hi:[1,0,1] neg_lo:[0,1,0]
    v_pk_fma_f32 v[46:47], v[50:51], v[98:99], v[46:47] op_sel:[1,1,0] op_sel_hi:[1,0,1] neg_lo:[0,1,0]
    v_cvt_pk_bf16_f32 v2, v44, v45
    v_cvt_pk_bf16_f32 v3, v46, v47
    ds_write_b64 v9, v[2:3] offset:528
    v_pk_mul_f32 v[36:37], v[48:49], v[40:41] op_sel:[0,0] op_sel_hi:[0,1]
    v_pk_mul_f32 v[38:39], v[50:51], v[42:43] op_sel:[0,0] op_sel_hi:[0,1]
    v_pk_fma_f32 v[36:37], v[48:49], v[40:41], v[36:37] op_sel:[1,1,0] op_sel_hi:[1,0,1] neg_lo:[0,1,0]
    v_pk_fma_f32 v[38:39], v[50:51], v[42:43], v[38:39] op_sel:[1,1,0] op_sel_hi:[1,0,1] neg_lo:[0,1,0]
    v_cvt_pk_bf16_f32 v4, v36, v37
    v_cvt_pk_bf16_f32 v5, v38, v39
    ds_write_b64 v9, v[4:5] offset:1056
    v_pk_mul_f32 v[44:45], v[36:37], v[96:97] op_sel:[0,0] op_sel_hi:[0,1]
    v_pk_mul_f32 v[46:47], v[38:39], v[98:99] op_sel:[0,0] op_sel_hi:[0,1]
    v_pk_fma_f32 v[44:45], v[36:37], v[96:97], v[44:45] op_sel:[1,1,0] op_sel_hi:[1,0,1] neg_lo:[0,1,0]
    v_pk_fma_f32 v[46:47], v[38:39], v[98:99], v[46:47] op_sel:[1,1,0] op_sel_hi:[1,0,1] neg_lo:[0,1,0]
    v_cvt_pk_bf16_f32 v2, v44, v45
    v_cvt_pk_bf16_f32 v3, v46, v47
    ds_write_b64 v9, v[2:3] offset:1584
    v_pk_mul_f32 v[48:49], v[36:37], v[40:41] op_sel:[0,0] op_sel_hi:[0,1]
    v_pk_mul_f32 v[50:51], v[38:39], v[42:43] op_sel:[0,0] op_sel_hi:[0,1]
    v_pk_fma_f32 v[48:49], v[36:37], v[40:41], v[48:49] op_sel:[1,1,0] op_sel_hi:[1,0,1] neg_lo:[0,1,0]
    v_pk_fma_f32 v[50:51], v[38:39], v[42:43], v[50:51] op_sel:[1,1,0] op_sel_hi:[1,0,1] neg_lo:[0,1,0]
    v_cvt_pk_bf16_f32 v4, v48, v49
    v_cvt_pk_bf16_f32 v5, v50, v51
    ds_write_b64 v9, v[4:5] offset:2112
    v_pk_mul_f32 v[44:45], v[48:49], v[96:97] op_sel:[0,0] op_sel_hi:[0,1]
    v_pk_mul_f32 v[46:47], v[50:51], v[98:99] op_sel:[0,0] op_sel_hi:[0,1]
    v_pk_fma_f32 v[44:45], v[48:49], v[96:97], v[44:45] op_sel:[1,1,0] op_sel_hi:[1,0,1] neg_lo:[0,1,0]
    v_pk_fma_f32 v[46:47], v[50:51], v[98:99], v[46:47] op_sel:[1,1,0] op_sel_hi:[1,0,1] neg_lo:[0,1,0]
    v_cvt_pk_bf16_f32 v2, v44, v45
    v_cvt_pk_bf16_f32 v3, v46, v47
    ds_write_b64 v9, v[2:3] offset:2640
    v_pk_mul_f32 v[36:37], v[48:49], v[40:41] op_sel:[0,0] op_sel_hi:[0,1]
    v_pk_mul_f32 v[38:39], v[50:51], v[42:43] op_sel:[0,0] op_sel_hi:[0,1]
    v_pk_fma_f32 v[36:37], v[48:49], v[40:41], v[36:37] op_sel:[1,1,0] op_sel_hi:[1,0,1] neg_lo:[0,1,0]
    v_pk_fma_f32 v[38:39], v[50:51], v[42:43], v[38:39] op_sel:[1,1,0] op_sel_hi:[1,0,1] neg_lo:[0,1,0]
    v_cvt_pk_bf16_f32 v4, v36, v37
    v_cvt_pk_bf16_f32 v5, v38, v39
    ds_write_b64 v9, v[4:5] offset:3168
    v_pk_mul_f32 v[44:45], v[36:37], v[96:97] op_sel:[0,0] op_sel_hi:[0,1]
    v_pk_mul_f32 v[46:47], v[38:39], v[98:99] op_sel:[0,0] op_sel_hi:[0,1]
    v_pk_fma_f32 v[44:45], v[36:37], v[96:97], v[44:45] op_sel:[1,1,0] op_sel_hi:[1,0,1] neg_lo:[0,1,0]
    v_pk_fma_f32 v[46:47], v[38:39], v[98:99], v[46:47] op_sel:[1,1,0] op_sel_hi:[1,0,1] neg_lo:[0,1,0]
    v_cvt_pk_bf16_f32 v2, v44, v45
    v_cvt_pk_bf16_f32 v3, v46, v47
    ds_write_b64 v9, v[2:3] offset:3696
    v_pk_mul_f32 v[48:49], v[36:37], v[40:41] op_sel:[0,0] op_sel_hi:[0,1]
    v_pk_mul_f32 v[50:51], v[38:39], v[42:43] op_sel:[0,0] op_sel_hi:[0,1]
    v_pk_fma_f32 v[48:49], v[36:37], v[40:41], v[48:49] op_sel:[1,1,0] op_sel_hi:[1,0,1] neg_lo:[0,1,0]
    v_pk_fma_f32 v[50:51], v[38:39], v[42:43], v[50:51] op_sel:[1,1,0] op_sel_hi:[1,0,1] neg_lo:[0,1,0]
    v_cvt_pk_bf16_f32 v4, v48, v49
    v_cvt_pk_bf16_f32 v5, v50, v51
    ds_write_b64 v9, v[4:5] offset:4224
    ds_read_b128 v[112:115], v10 offset:0
    ds_read_b128 v[116:119], v10 offset:64
    ds_read_b128 v[120:123], v10 offset:128
    ds_read_b128 v[124:127], v10 offset:192
    s_waitcnt lgkmcnt(3)
    v_mfma_f32_16x16x32_bf16 v[24:27], v[112:115], v[52:55], 0
    s_waitcnt lgkmcnt(2)
    v_mfma_f32_16x16x32_bf16 v[24:27], v[116:119], v[56:59], v[24:27]
    s_waitcnt lgkmcnt(1)
    v_mfma_f32_16x16x32_bf16 v[24:27], v[120:123], v[60:63], v[24:27]
    s_waitcnt lgkmcnt(0)
    v_mfma_f32_16x16x32_bf16 v[24:27], v[124:127], v[64:67], v[24:27]
    ds_read_b128 v[112:115], v10 offset:256
    ds_read_b128 v[116:119], v10 offset:320
    ds_read_b128 v[120:123], v10 offset:384
    ds_read_b128 v[124:127], v10 offset:448
    s_waitcnt lgkmcnt(3)
    v_mfma_f32_16x16x32_bf16 v[24:27], v[112:115], v[68:71], v[24:27]
    s_waitcnt lgkmcnt(2)
    v_mfma_f32_16x16x32_bf16 v[24:27], v[116:119], v[72:75], v[24:27]
    s_waitcnt lgkmcnt(1)
    v_mfma_f32_16x16x32_bf16 v[24:27], v[120:123], v[76:79], v[24:27]
    s_waitcnt lgkmcnt(0)
    v_mfma_f32_16x16x32_bf16 v[24:27], v[124:127], v[80:83], v[24:27]
    v_lshlrev_b32 v8, 16, v8
    s_mov_b64 exec, 1
    v_add_f32 v16, v16, v8
    s_mov_b64 exec, -1
    v_cvt_pk_bf16_f32 v52, v16, v16
    v_cvt_pk_bf16_f32 v53, v17, v17
    v_cvt_pk_bf16_f32 v54, v18, v18
    v_cvt_pk_bf16_f32 v55, v19, v19
    v_cvt_pk_bf16_f32 v56, v20, v20
    v_cvt_pk_bf16_f32 v57, v21, v21
    v_cvt_pk_bf16_f32 v58, v22, v22
    v_cvt_pk_bf16_f32 v59, v23, v23
    v_cvt_pk_bf16_f32 v60, v24, v24
    v_cvt_pk_bf16_f32 v61, v25, v25
    v_cvt_pk_bf16_f32 v62, v26, v26
    v_cvt_pk_bf16_f32 v63, v27, v27
    ds_write_b128 v11, v[52:55]
    ds_write_b128 v12, v[56:59]
    ds_write_b64 v13, v[60:61]
    ds_write_b64 v13, v[62:63] offset:128
    v_lshlrev_b32 v2, 3, v0
    v_lshlrev_b32 v3, 2, v0
    v_add_u32 v4, 128, v3
    v_cmp_gt_u32 vcc, 32, v0
    s_nop 1
    v_cndmask_b32 v2, v4, v2, vcc
    v_lshl_add_u32 v2, v2, 2, s8
    v_lshl_add_u32 v4, v0, 3, s8
    v_add_u32 v3, s8, v3
    ds_read_b128 v[64:67], v2
    ds_read_b128 v[68:71], v2 offset:16
    ds_read_b64 v[72:73], v4 offset:1536
    ds_read_b32 v74, v4 offset:1544
    ds_read_b32 v76, v3 offset:2048
    ds_read_b32 v77, v3 offset:2052
    ds_read_b32 v78, v3 offset:2304
    ds_read_b32 v79, v3 offset:2308
    v_lshlrev_b32 v5, 4, v0
    v_sub_u32 v5, 1008, v5
    s_mul_i32 s12, s4, 4112
    s_add_u32 s12, s12, 10485760
    s_mov_b32 s13, 0xffff
    v_and_b32 v6, 1, v0
    v_sub_u32 v6, 0, v6
    v_or_b32 v6, 0xffff, v6
    s_waitcnt lgkmcnt(0)
    v_bfi_b32 v84, s13, v68, v67
    v_mov_b32 v85, v66
    v_bfi_b32 v86, s13, v66, v65
    v_mov_b32 v87, v64
    s_mov_b64 exec, 0xffffffff
    v_bfi_b32 v84, s13, v71, v70
    v_bfi_b32 v85, s13, v69, v68
    v_bfi_b32 v86, s13, v67, v66
    v_bfi_b32 v87, s13, v65, v64
    s_mov_b64 exec, -1
    buffer_store_dwordx4 v[84:87], v5, s[48:51], s12 offen offset:3072
    v_mov_b32 v88, v74
    v_mov_b32 v89, v73
    v_bfi_b32 v90, s13, v73, v72
    v_mov_b32 v91, v72
    buffer_store_dwordx4 v[88:91], v5, s[48:51], s12 offen offset:2048
    v_mov_b32 v92, v77
    v_bfi_b32 v93, v6, v77, v76
    v_mov_b32 v94, v76
    v_mov_b32 v95, v76
    buffer_store_dwordx4 v[92:95], v5, s[48:51], s12 offen offset:1024
    v_mov_b32 v96, v79
    v_bfi_b32 v97, v6, v79, v78
    v_mov_b32 v98, v78
    v_mov_b32 v99, v78
    buffer_store_dwordx4 v[96:99], v5, s[48:51], s12 offen offset:0
    v_mov_b32 v100, 0
    v_mov_b32 v101, 0
    v_mov_b32 v102, 0
    v_mov_b32 v103, 0
    v_mov_b32 v2, 4096
    s_mov_b64 exec, 1
    buffer_store_dwordx4 v[100:103], v2, s[48:51], s12 offen
    s_endpgm
K1_TRANS:
    s_mul_i32 s7, s3, 13312
    s_mov_b32 s52, s16
    s_and_b32 s53, s17, 0xffff
    s_mov_b32 s54, 2621440
    s_mov_b32 s55, 0x20000
    s_mul_i32 s5, s4, 205
    s_lshr_b32 s5, s5, 11
    s_mul_i32 s6, s5, 10
    s_sub_u32 s6, s4, s6
    s_mul_i32 s8, s5, 81920
    s_lshl_b32 s9, s6, 7
    s_add_u32 s8, s8, s9
    v_lshrrev_b32 v2, 3, v0
    v_and_b32 v3, 7, v0
    v_xor_b32 v4, v2, v3
    v_mul_u32_u24 v5, 1280, v2
    v_lshl_add_u32 v6, v4, 4, v5
    s_add_u32 m0, s7, 0
    s_add_u32 s10, s8, 0
    buffer_load_dwordx4 v6, s[52:55], s10 offen lds
    s_add_u32 m0, s7, 1024
    s_add_u32 s10, s8, 10240
    buffer_load_dwordx4 v6, s[52:55], s10 offen lds
    s_add_u32 m0, s7, 2048
    s_add_u32 s10, s8, 20480
    buffer_load_dwordx4 v6, s[52:55], s10 offen lds
    s_add_u32 m0, s7, 3072
    s_add_u32 s10, s8, 30720
    buffer_load_dwordx4 v6, s[52:55], s10 offen lds
    s_add_u32 m0, s7, 4096
    s_add_u32 s10, s8, 40960
    buffer_load_dwordx4 v6, s[52:55], s10 offen lds
    s_add_u32 m0, s7, 5120
    s_add_u32 s10, s8, 51200
    buffer_load_dwordx4 v6, s[52:55], s10 offen lds
    s_add_u32 m0, s7, 6144
    s_add_u32 s10, s8, 61440
    buffer_load_dwordx4 v6, s[52:55], s10 offen lds
    s_add_u32 m0, s7, 7168
    s_add_u32 s10, s8, 71680
    buffer_load_dwordx4 v6, s[52:55], s10 offen lds
    v_lshrrev_b32 v2, 4, v0
    v_bfe_u32 v8, v0, 2, 2
    v_lshl_add_u32 v9, v2, 3, v8
    v_bfe_u32 v10, v0, 1, 1
    v_lshl_add_u32 v9, v10, 5, v9
    v_lshlrev_b32 v9, 7, v9
    v_and_b32 v10, 1, v0
    v_lshl_add_u32 v9, v10, 3, v9
    v_lshl_add_u32 v9, v8, 4, v9
    v_xor_b32 v16, 0, v9
    v_add_u32 v16, s7, v16
    v_xor_b32 v17, 16, v9
    v_add_u32 v17, s7, v17
    v_xor_b32 v18, 32, v9
    v_add_u32 v18, s7, v18
    v_xor_b32 v19, 48, v9
    v_add_u32 v19, s7, v19
    v_xor_b32 v20, 64, v9
    v_add_u32 v20, s7, v20
    v_xor_b32 v21, 80, v9
    v_add_u32 v21, s7, v21
    v_xor_b32 v22, 96, v9
    v_add_u32 v22, s7, v22
    v_xor_b32 v23, 112, v9
    v_add_u32 v23, s7, v23
    v_lshlrev_b32 v11, 12, v3
    v_lshl_add_u32 v11, v2, 4, v11
    v_bfe_u32 v10, v0, 3, 1
    v_lshl_add_u32 v11, v10, 6, v11
    s_lshl_b32 s10, s6, 18
    s_lshl_b32 s11, s5, 7
    s_add_u32 s10, s10, s11
    s_add_u32 s10, s10, 7864320
    s_waitcnt vmcnt(0)
    ds_read_b64_tr_b16 v[32:33], v16
    ds_read_b64_tr_b16 v[34:35], v20 offset:512
    ds_read_b64_tr_b16 v[36:37], v17
    ds_read_b64_tr_b16 v[38:39], v21 offset:512
    ds_read_b64_tr_b16 v[40:41], v18
    ds_read_b64_tr_b16 v[42:43], v22 offset:512
    ds_read_b64_tr_b16 v[44:45], v19
    ds_read_b64_tr_b16 v[46:47], v23 offset:512
    ds_read_b64_tr_b16 v[48:49], v20
    ds_read_b64_tr_b16 v[50:51], v16 offset:512
    ds_read_b64_tr_b16 v[52:53], v21
    ds_read_b64_tr_b16 v[54:55], v17 offset:512
    ds_read_b64_tr_b16 v[56:57], v22
    ds_read_b64_tr_b16 v[58:59], v18 offset:512
    ds_read_b64_tr_b16 v[60:61], v23
    ds_read_b64_tr_b16 v[62:63], v19 offset:512
    s_waitcnt lgkmcnt(14)
    buffer_store_dwordx4 v[32:35], v11, s[48:51], s10 offen
    s_add_u32 s10, s10, 32768
    s_waitcnt lgkmcnt(12)
    buffer_store_dwordx4 v[36:39], v11, s[48:51], s10 offen
    s_add_u32 s10, s10, 32768
    s_waitcnt lgkmcnt(10)
    buffer_store_dwordx4 v[40:43], v11, s[48:51], s10 offen
    s_add_u32 s10, s10, 32768
    s_waitcnt lgkmcnt(8)
    buffer_store_dwordx4 v[44:47], v11, s[48:51], s10 offen
    s_add_u32 s10, s10, 32768
    s_waitcnt lgkmcnt(6)
    buffer_store_dwordx4 v[48:51], v11, s[48:51], s10 offen
    s_add_u32 s10, s10, 32768
    s_waitcnt lgkmcnt(4)
    buffer_store_dwordx4 v[52:55], v11, s[48:51], s10 offen
    s_add_u32 s10, s10, 32768
    s_waitcnt lgkmcnt(2)
    buffer_store_dwordx4 v[56:59], v11, s[48:51], s10 offen
    s_add_u32 s10, s10, 32768
    s_waitcnt lgkmcnt(0)
    buffer_store_dwordx4 v[60:63], v11, s[48:51], s10 offen
    s_endpgm
K1_WOT:
    s_mul_i32 s7, s3, 13312
    s_mov_b32 s52, s20
    s_and_b32 s53, s21, 0xffff
    s_mov_b32 s54, 819200
    s_mov_b32 s55, 0x20000
    s_mul_i32 s5, s4, 205
    s_lshr_b32 s5, s5, 10
    s_mul_i32 s6, s5, 5
    s_sub_u32 s6, s4, s6
    s_mul_i32 s8, s5, 51200
    s_lshl_b32 s9, s6, 8
    s_add_u32 s8, s8, s9
    v_lshrrev_b32 v2, 4, v0
    v_and_b32 v3, 15, v0
    v_lshlrev_b32 v4, 2, v2
    v_xor_b32 v4, v4, v3
    v_mul_u32_u24 v5, 1280, v2
    v_lshl_add_u32 v6, v4, 4, v5
    s_add_u32 m0, s7, 0
    s_add_u32 s10, s8, 0
    buffer_load_dwordx4 v6, s[52:55], s10 offen lds
    s_add_u32 m0, s7, 1024
    s_add_u32 s10, s8, 5120
    buffer_load_dwordx4 v6, s[52:55], s10 offen lds
    s_add_u32 m0, s7, 2048
    s_add_u32 s10, s8, 10240
    buffer_load_dwordx4 v6, s[52:55], s10 offen lds
    s_add_u32 m0, s7, 3072
    s_add_u32 s10, s8, 15360
    buffer_load_dwordx4 v6, s[52:55], s10 offen lds
    s_add_u32 m0, s7, 4096
    s_add_u32 s10, s8, 20480
    buffer_load_dwordx4 v6, s[52:55], s10 offen lds
    s_add_u32 m0, s7, 5120
    s_add_u32 s10, s8, 25600
    buffer_load_dwordx4 v6, s[52:55], s10 offen lds
    s_add_u32 m0, s7, 6144
    s_add_u32 s10, s8, 30720
    buffer_load_dwordx4 v6, s[52:55], s10 offen lds
    s_add_u32 m0, s7, 7168
    s_add_u32 s10, s8, 35840
    buffer_load_dwordx4 v6, s[52:55], s10 offen lds
    s_add_u32 m0, s7, 8192
    s_add_u32 s10, s8, 40960
    buffer_load_dwordx4 v6, s[52:55], s10 offen lds
    s_add_u32 m0, s7, 9216
    s_add_u32 s10, s8, 46080
    buffer_load_dwordx4 v6, s[52:55], s10 offen lds
    v_bfe_u32 v8, v0, 2, 2
    v_lshlrev_b32 v9, 8, v8
    v_and_b32 v10, 3, v0
    v_lshl_add_u32 v9, v10, 3, v9
    v_bfe_u32 v10, v0, 4, 1
    v_lshl_add_u32 v9, v10, 5, v9
    v_lshrrev_b32 v10, 5, v0
    v_xor_b32 v10, v10, v8
    v_lshl_add_u32 v9, v10, 6, v9
    v_xor_b32 v17, 128, v9
    v_add_u32 v16, s7, v9
    v_add_u32 v17, s7, v17
    s_lshl_b32 s11, s6, 3
    v_add_u32 v12, s11, v2
    v_mul_u32_u24 v13, 205, v12
    v_lshrrev_b32 v13, 10, v13
    v_mul_u32_u24 v13, 95, v13
    v_add_u32 v12, v12, v13
    v_lshlrev_b32 v12, 10, v12
    v_lshl_add_u32 v18, v3, 4, v12
    v_add_u32 v12, s11, v2
    v_add_u32 v12, 4, v12
    v_mul_u32_u24 v13, 205, v12
    v_lshrrev_b32 v13, 10, v13
    v_mul_u32_u24 v13, 95, v13
    v_add_u32 v12, v12, v13
    v_lshlrev_b32 v12, 10, v12
    v_lshl_add_u32 v19, v3, 4, v12
    s_lshr_b32 s9, s5, 2
    s_mul_i32 s9, s9, 25600
    s_add_u32 s9, s9, 19922944
    s_and_b32 s12, s5, 3
    s_lshl_b32 s13, s12, 8
    s_add_u32 s13, s13, s9
    s_add_u32 s13, s13, 20480
    s_mul_i32 s12, s12, 5120
    s_add_u32 s9, s9, s12
    s_waitcnt vmcnt(0)
    ds_read_b64_tr_b16 v[32:33], v16 offset:0
    ds_read_b64_tr_b16 v[34:35], v16 offset:2048
    ds_read_b64_tr_b16 v[36:37], v17 offset:0
    ds_read_b64_tr_b16 v[38:39], v17 offset:2048
    ds_read_b64_tr_b16 v[40:41], v16 offset:1024
    ds_read_b64_tr_b16 v[42:43], v16 offset:3072
    ds_read_b64_tr_b16 v[44:45], v17 offset:1024
    ds_read_b64_tr_b16 v[46:47], v17 offset:3072
    ds_read_b64_tr_b16 v[48:49], v16 offset:5120
    ds_read_b64_tr_b16 v[50:51], v16 offset:7168
    ds_read_b64_tr_b16 v[52:53], v17 offset:5120
    ds_read_b64_tr_b16 v[54:55], v17 offset:7168
    s_waitcnt lgkmcnt(4)
    ds_read_b64_tr_b16 v[56:57], v16 offset:6144
    ds_read_b64_tr_b16 v[58:59], v16 offset:8192
    ds_read_b64_tr_b16 v[60:61], v17 offset:6144
    ds_read_b64_tr_b16 v[62:63], v17 offset:8192
    ds_read_b64_tr_b16 v[64:65], v16 offset:4096
    ds_read_b64_tr_b16 v[66:67], v16 offset:9216
    ds_read_b64_tr_b16 v[68:69], v17 offset:4096
    ds_read_b64_tr_b16 v[70:71], v17 offset:9216
    s_waitcnt lgkmcnt(0)
    buffer_store_dwordx4 v[32:35], v18, s[48:51], s9 offen offset:0
    buffer_store_dwordx4 v[36:39], v19, s[48:51], s9 offen offset:0
    buffer_store_dwordx4 v[40:43], v18, s[48:51], s9 offen offset:256
    buffer_store_dwordx4 v[44:47], v19, s[48:51], s9 offen offset:256
    buffer_store_dwordx4 v[48:51], v18, s[48:51], s9 offen offset:512
    buffer_store_dwordx4 v[52:55], v19, s[48:51], s9 offen offset:512
    buffer_store_dwordx4 v[56:59], v18, s[48:51], s9 offen offset:768
    buffer_store_dwordx4 v[60:63], v19, s[48:51], s9 offen offset:768
    buffer_store_dwordx4 v[64:67], v18, s[48:51], s13 offen offset:0
    buffer_store_dwordx4 v[68:71], v19, s[48:51], s13 offen offset:0
    s_endpgm
K1_EXIT:
    s_endpgm
.section .rodata,"a"
.p2align 6
.amdhsa_kernel k1_kernel
  .amdhsa_next_free_vgpr 128
  .amdhsa_next_free_sgpr 102
  .amdhsa_accum_offset 128
  .amdhsa_group_segment_fixed_size 0
  .amdhsa_kernarg_size 128
  .amdhsa_user_sgpr_count 2
  .amdhsa_user_sgpr_kernarg_segment_ptr 1
  .amdhsa_system_sgpr_workgroup_id_x 1
.end_amdhsa_kernel
.text
.globl k2_kernel
.p2align 8
.type k2_kernel,@function
k2_kernel:
    s_cmp_ge_u32 s2, 256
    s_cbranch_scc1 K2_EXIT
    s_load_dwordx2 s[4:5], s[0:1], 120
    s_load_dwordx2 s[6:7], s[0:1], 104
    v_lshrrev_b32 v1, 6, v0
    v_and_b32 v0, 63, v0
    v_readfirstlane_b32 s3, v1
    s_and_b32 s18, s2, 7
    s_lshl_b32 s18, s18, 2
    s_bfe_u32 s17, s2, 0x20003
    s_add_u32 s18, s18, s17
    s_lshr_b32 s17, s2, 5
    s_mul_i32 s16, s18, 81920
    s_cmp_ge_u32 s3, 8
    s_cbranch_scc1 K2_CONV
    s_and_b32 s19, s3, 3
    s_mov_b32 s60, 0x07060302
    s_lshr_b32 s20, s3, 2
    s_setprio 1
    s_lshl_b32 s21, s17, 3
    s_lshl_b32 s22, s19, 1
    s_add_u32 s21, s21, s22
    s_mul_i32 s22, s21, 1280
    s_add_u32 s22, s22, s16
    v_lshlrev_b32 v8, 4, v0
    v_lshlrev_b32 v9, 3, v0
    v_mov_b32 v20, 0
    v_mov_b32 v21, 0
    v_mov_b32 v26, 0
    v_mov_b32 v27, 0
    s_waitcnt lgkmcnt(0)
    s_mov_b32 s8, s4
    s_and_b32 s9, s5, 0xffff
    s_mov_b32 s10, 22020096
    s_mov_b32 s11, 0x20000
    s_mul_i32 s23, s20, 40960
    s_lshl_b32 s55, s19, 10
    s_add_u32 s55, s55, s23
    s_add_u32 s56, s16, 2621440
    s_add_u32 s56, s56, s55
    buffer_load_dwordx4 v[16:19], v8, s[8:11], s22 offen
    buffer_load_dwordx4 v[22:25], v8, s[8:11], s22 offen offset:1280
    s_mov_b64 exec, 0xffffffff
    buffer_load_dwordx2 v[20:21], v9, s[8:11], s22 offen offset:1024
    buffer_load_dwordx2 v[26:27], v9, s[8:11], s22 offen offset:2304
    s_mov_b64 exec, -1
    s_add_u32 m0, s55, 0
    s_add_u32 s26, s56, 0
    buffer_load_dwordx4 v8, s[8:11], s26 offen lds
    s_add_u32 m0, s55, 4096
    s_add_u32 s26, s56, 4096
    buffer_load_dwordx4 v8, s[8:11], s26 offen lds
    v_and_b32 v10, 31, v0
    v_lshrrev_b32 v11, 5, v0
    v_lshlrev_b32 v4, 4, v11
    v_lshl_add_u32 v4, v10, 5, v4
    s_mov_b32 s14, 0xfffff
    s_mov_b32 s15, 0xfffff
    s_add_u32 s13, s16, 5242880
    s_add_u32 s13, s13, s23
    s_mov_b32 s27, 0x3f803f80
    v_mov_b32 v40, s27
    v_mov_b32 v41, s27
    v_mov_b32 v42, s27
    v_mov_b32 v43, s27
    v_mov_b32 v44, s27
    v_mov_b32 v45, s27
    v_mov_b32 v46, s27
    v_mov_b32 v47, s27
    v_mov_b32 v48, s27
    v_mov_b32 v49, s27
    v_mov_b32 v50, s27
    v_mov_b32 v51, s27
    v_mov_b32 v52, s27
    v_mov_b32 v53, s27
    v_mov_b32 v54, s27
    v_mov_b32 v55, s27
    v_mov_b32 v56, s27
    v_mov_b32 v57, s27
    v_mov_b32 v58, s27
    v_mov_b32 v59, s27
    v_mov_b32 v60, s27
    v_mov_b32 v61, s27
    v_mov_b32 v62, s27
    v_mov_b32 v63, s27
    v_mov_b32 v64, s27
    v_mov_b32 v65, s27
    v_mov_b32 v66, s27
    v_mov_b32 v67, s27
    v_mov_b32 v68, s27
    v_mov_b32 v69, s27
    v_mov_b32 v70, s27
    v_mov_b32 v71, s27
    s_mov_b64 exec, s[14:15]
    buffer_load_dwordx4 v[40:43], v4, s[8:11], s13 offen
    buffer_load_dwordx4 v[44:47], v4, s[8:11], s13 offen offset:640
    s_mov_b64 exec, -1
    s_add_u32 s13, s13, 1280
    s_mov_b64 exec, s[14:15]
    buffer_load_dwordx4 v[48:51], v4, s[8:11], s13 offen
    buffer_load_dwordx4 v[52:55], v4, s[8:11], s13 offen offset:640
    s_mov_b64 exec, -1
    s_add_u32 s13, s13, 1280
    s_mov_b64 exec, s[14:15]
    buffer_load_dwordx4 v[56:59], v4, s[8:11], s13 offen
    buffer_load_dwordx4 v[60:63], v4, s[8:11], s13 offen offset:640
    s_mov_b64 exec, -1
    s_add_u32 s13, s13, 1280
    v_add_u32 v2, s23, v8
    v_add_u32 v3, s23, v9
    v_add_u32 v3, 1024, v3
    v_mov_b32 v32, 0x3f80
    v_mov_b32 v33, 0
    v_mov_b32 v38, 0x3f80
    v_mov_b32 v39, 0
    s_add_u32 s21, s21, s20
    s_lshr_b32 s24, s18, 3
    s_mul_i32 s24, s24, 20480
    s_lshr_b32 s48, s21, 1
    s_mul_i32 s48, s48, 81920
    s_add_u32 s48, s48, s24
    s_and_b32 s28, s21, 1
    s_lshl_b32 s28, s28, 11
    s_add_u32 s48, s48, s28
    s_add_u32 s48, s48, 16777216
    s_and_b32 s49, s18, 7
    s_lshl_b32 s49, s49, 7
    s_add_u32 s49, s49, s48
    s_add_u32 s49, s49, 16384
    s_bfe_u32 s25, s18, 0x20001
    s_lshl_b32 s25, s25, 12
    s_add_u32 s48, s48, s25
    s_and_b32 s25, s18, 1
    s_lshl_b32 s25, s25, 9
    s_add_u32 s48, s48, s25
    v_and_b32 v15, 15, v0
    v_bfe_u32 v1, v0, 4, 1
    v_lshlrev_b32 v1, 10, v1
    v_lshl_add_u32 v7, v15, 3, v1
    v_lshl_add_u32 v1, v15, 4, v1
    v_lshrrev_b32 v15, 5, v0
    v_lshl_add_u32 v1, v15, 8, v1
    v_mov_b32 v152, -1
    v_mov_b32 v153, -1
    v_mov_b32 v154, -1
    v_mov_b32 v155, -1
    s_lshl_b32 s50, s3, 12
    s_xor_b32 s51, s50, 0x4000
    s_mul_i32 s52, s19, 25600
    s_add_u32 s52, s52, 81920
    s_cmp_eq_u32 s19, 3
    s_cselect_b32 s52, 56320, s52
    s_and_b32 s40, s2, 7
    s_lshl_b32 s40, s40, 2
    s_bfe_u32 s41, s2, 0x20003
    s_add_u32 s40, s40, s41
    s_lshr_b32 s41, s2, 5
    s_mov_b32 s36, s6
    s_and_b32 s37, s7, 0xffff
    s_mov_b32 s38, 2621440
    s_mov_b32 s39, 0x20000
    s_lshl_b32 s42, s3, 2
    s_lshl_b32 s43, s40, 8
    s_add_u32 s43, s43, 20971520
    s_mul_i32 s44, s40, 81920
    s_mul_i32 s45, s41, 160
    s_add_u32 s44, s44, s45
    s_mul_i32 s53, s40, 81920
    s_mul_i32 s25, s19, 20480
    s_add_u32 s53, s53, s25
    s_and_b32 s61, s41, 0
    s_xor_b32 s61, s61, s20
    s_lshl_b32 s25, s61, 11
    s_add_u32 s53, s53, s25
    s_add_u32 s53, s53, 16777216
    s_and_b32 s54, s19, 1
    s_mul_i32 s54, s54, 20480
    s_lshr_b32 s25, s19, 1
    s_mul_i32 s25, s25, 92160
    s_add_u32 s54, s54, s25
    s_mul_i32 s25, s61, 10240
    s_add_u32 s54, s54, s25
    s_waitcnt vmcnt(6)
    s_barrier
    ds_read_b128 v[28:31], v2 offset:0
    s_mov_b64 exec, 0xffffffff
    ds_read_b64 v[32:33], v3 offset:0
    s_mov_b64 exec, -1
    s_waitcnt lgkmcnt(0)
    v_mfma_f32_32x32x16_bf16 v[72:87], v[28:31], v[16:19], 0
    v_mfma_f32_32x32x16_bf16 v[88:103], v[28:31], v[22:25], 0
    v_mfma_f32_32x32x8bf16_1k v[72:87], v[32:33], v[20:21], v[72:87]
    v_mfma_f32_32x32x8bf16_1k v[88:103], v[32:33], v[26:27], v[88:103]
    s_nop 10
    v_max3_f32 v5, v72, v73, v74
    v_max3_f32 v5, v5, v75, v76
    v_max3_f32 v5, v5, v77, v78
    v_max3_f32 v5, v5, v79, v80
    v_max3_f32 v5, v5, v81, v82
    v_max3_f32 v5, v5, v83, v84
    v_max3_f32 v5, v5, v85, v86
    v_max_f32 v5, v5, v87
    v_mov_b32 v8, v5
    s_nop 1
    v_permlane32_swap_b32 v5, v8
    v_max_f32 v5, v5, v8
    v_max3_f32 v6, v88, v89, v90
    v_max3_f32 v6, v6, v91, v92
    v_max3_f32 v6, v6, v93, v94
    v_max3_f32 v6, v6, v95, v96
    v_max3_f32 v6, v6, v97, v98
    v_max3_f32 v6, v6, v99, v100
    v_max3_f32 v6, v6, v101, v102
    v_max_f32 v6, v6, v103
    v_mov_b32 v9, v6
    s_nop 1
    v_permlane32_swap_b32 v6, v9
    v_max_f32 v6, v6, v9
    v_cvt_pk_bf16_f32 v5, -v5, 0
    v_cvt_pk_bf16_f32 v6, -v6, 0
    s_mov_b32 exec_lo, 0
    v_mov_b32 v20, v5
    v_mov_b32 v26, v6
    s_mov_b32 exec_lo, -1
    v_lshlrev_b32 v5, 16, v5
    v_lshlrev_b32 v6, 16, v6
    v_mfma_f32_32x32x16_bf16 v[72:87], v[28:31], v[16:19], 0
    v_mfma_f32_32x32x8bf16_1k v[72:87], v[32:33], v[20:21], v[72:87]
    ds_read_b128 v[34:37], v2 offset:1280
    s_mov_b64 exec, 0xffffffff
    ds_read_b64 v[38:39], v3 offset:1280
    s_mov_b64 exec, -1
    v_mfma_f32_32x32x16_bf16 v[88:103], v[28:31], v[22:25], 0
    s_nop 6
    v_exp_f32 v72, v72
    v_exp_f32 v73, v73
    v_exp_f32 v74, v74
    v_exp_f32 v75, v75
    v_cvt_pk_bf16_f32 v104, v72, v73
    v_exp_f32 v76, v76
    v_exp_f32 v77, v77
    v_cvt_pk_bf16_f32 v105, v74, v75
    v_exp_f32 v78, v78
    v_exp_f32 v79, v79
    v_cvt_pk_bf16_f32 v106, v76, v77
    v_exp_f32 v80, v80
    v_mfma_f32_32x32x8bf16_1k v[88:103], v[32:33], v[26:27], v[88:103]
    v_exp_f32 v81, v81
    v_cvt_pk_bf16_f32 v107, v78, v79
    v_exp_f32 v82, v82
    v_exp_f32 v83, v83
    v_cvt_pk_bf16_f32 v108, v80, v81
    v_exp_f32 v84, v84
    v_exp_f32 v85, v85
    v_cvt_pk_bf16_f32 v109, v82, v83
    v_exp_f32 v86, v86
    v_exp_f32 v87, v87
    v_cvt_pk_bf16_f32 v110, v84, v85
    v_cvt_pk_bf16_f32 v111, v86, v87
    s_mov_b64 exec, s[14:15]
    buffer_load_dwordx4 v[64:67], v4, s[8:11], s13 offen
    buffer_load_dwordx4 v[68:71], v4, s[8:11], s13 offen offset:640
    s_mov_b64 exec, -1
    s_add_u32 s13, s13, 1280
    s_waitcnt lgkmcnt(0)
    v_mfma_f32_32x32x16_bf16 v[72:87], v[34:37], v[16:19], 0
    v_exp_f32 v88, v88
    v_exp_f32 v89, v89
    v_exp_f32 v90, v90
    v_exp_f32 v91, v91
    v_cvt_pk_bf16_f32 v112, v88, v89
    v_exp_f32 v92, v92
    s_waitcnt vmcnt(6)
    v_mfma_f32_32x32x16_bf16 v[120:135], v[40:43], v[104:107], 0
    v_exp_f32 v93, v93
    v_cvt_pk_bf16_f32 v113, v90, v91
    v_exp_f32 v94, v94
    v_exp_f32 v95, v95
    v_cvt_pk_bf16_f32 v114, v92, v93
    v_exp_f32 v96, v96
    v_mfma_f32_32x32x8bf16_1k v[72:87], v[38:39], v[20:21], v[72:87]
    v_exp_f32 v97, v97
    v_cvt_pk_bf16_f32 v115, v94, v95
    v_exp_f32 v98, v98
    v_exp_f32 v99, v99
    v_cvt_pk_bf16_f32 v116, v96, v97
    v_exp_f32 v100, v100
    v_mfma_f32_32x32x16_bf16 v[120:135], v[44:47], v[108:111], v[120:135]
    v_exp_f32 v101, v101
    v_cvt_pk_bf16_f32 v117, v98, v99
    v_exp_f32 v102, v102
    v_exp_f32 v103, v103
    v_cvt_pk_bf16_f32 v118, v100, v101
    v_cvt_pk_bf16_f32 v119, v102, v103
    ds_read_b128 v[28:31], v2 offset:2560
    s_mov_b64 exec, 0xffffffff
    ds_read_b64 v[32:33], v3 offset:2560
    s_mov_b64 exec, -1
    v_mfma_f32_32x32x16_bf16 v[88:103], v[34:37], v[22:25], 0
    v_exp_f32 v72, v72
    v_exp_f32 v73, v73
    v_exp_f32 v74, v74
    v_exp_f32 v75, v75
    v_cvt_pk_bf16_f32 v104, v72, v73
    v_exp_f32 v76, v76
    v_mfma_f32_32x32x16_bf16 v[136:151], v[40:43], v[112:115], 0
    v_exp_f32 v77, v77
    v_cvt_pk_bf16_f32 v105, v74, v75
    v_exp_f32 v78, v78
    v_exp_f32 v79, v79
    v_cvt_pk_bf16_f32 v106, v76, v77
    v_exp_f32 v80, v80
    v_mfma_f32_32x32x8bf16_1k v[88:103], v[38:39], v[26:27], v[88:103]
    v_exp_f32 v81, v81
    v_cvt_pk_bf16_f32 v107, v78, v79
    v_exp_f32 v82, v82
    v_exp_f32 v83, v83
    v_cvt_pk_bf16_f32 v108, v80, v81
    v_exp_f32 v84, v84
    v_mfma_f32_32x32x16_bf16 v[136:151], v[44:47], v[116:119], v[136:151]
    v_exp_f32 v85, v85
    v_cvt_pk_bf16_f32 v109, v82, v83
    v_exp_f32 v86, v86
    v_exp_f32 v87, v87
    v_cvt_pk_bf16_f32 v110, v84, v85
    v_cvt_pk_bf16_f32 v111, v86, v87
    s_mov_b64 exec, s[14:15]
    buffer_load_dwordx4 v[40:43], v4, s[8:11], s13 offen
    buffer_load_dwordx4 v[44:47], v4, s[8:11], s13 offen offset:640
    s_mov_b64 exec, -1
    s_add_u32 s13, s13, 1280
    s_waitcnt lgkmcnt(0)
    v_mfma_f32_32x32x16_bf16 v[72:87], v[28:31], v[16:19], 0
    v_exp_f32 v88, v88
    v_exp_f32 v89, v89
    v_exp_f32 v90, v90
    v_exp_f32 v91, v91
    v_cvt_pk_bf16_f32 v112, v88, v89
    v_exp_f32 v92, v92
    s_waitcnt vmcnt(6)
    v_mfma_f32_32x32x16_bf16 v[120:135], v[48:51], v[104:107], v[120:135]
    v_exp_f32 v93, v93
    v_cvt_pk_bf16_f32 v113, v90, v91
    v_exp_f32 v94, v94
    v_exp_f32 v95, v95
    v_cvt_pk_bf16_f32 v114, v92, v93
    v_exp_f32 v96, v96
    v_mfma_f32_32x32x8bf16_1k v[72:87], v[32:33], v[20:21], v[72:87]
    v_exp_f32 v97, v97
    v_cvt_pk_bf16_f32 v115, v94, v95
    v_exp_f32 v98, v98
    v_exp_f32 v99, v99
    v_cvt_pk_bf16_f32 v116, v96, v97
    v_exp_f32 v100, v100
    v_mfma_f32_32x32x16_bf16 v[120:135], v[52:55], v[108:111], v[120:135]
    v_exp_f32 v101, v101
    v_cvt_pk_bf16_f32 v117, v98, v99
    v_exp_f32 v102, v102
    v_exp_f32 v103, v103
    v_cvt_pk_bf16_f32 v118, v100, v101
    v_cvt_pk_bf16_f32 v119, v102, v103
    ds_read_b128 v[34:37], v2 offset:3840
    s_mov_b64 exec, 0xffffffff
    ds_read_b64 v[38:39], v3 offset:3840
    s_mov_b64 exec, -1
    v_mfma_f32_32x32x16_bf16 v[88:103], v[28:31], v[22:25], 0
    v_exp_f32 v72, v72
    v_exp_f32 v73, v73
    v_exp_f32 v74, v74
    v_exp_f32 v75, v75
    v_cvt_pk_bf16_f32 v104, v72, v73
    v_exp_f32 v76, v76
    v_mfma_f32_32x32x16_bf16 v[136:151], v[48:51], v[112:115], v[136:151]
    v_exp_f32 v77, v77
    v_cvt_pk_bf16_f32 v105, v74, v75
    v_exp_f32 v78, v78
    v_exp_f32 v79, v79
    v_cvt_pk_bf16_f32 v106, v76, v77
    v_exp_f32 v80, v80
    v_mfma_f32_32x32x8bf16_1k v[88:103], v[32:33], v[26:27], v[88:103]
    v_exp_f32 v81, v81
    v_cvt_pk_bf16_f32 v107, v78, v79
    v_exp_f32 v82, v82
    v_exp_f32 v83, v83
    v_cvt_pk_bf16_f32 v108, v80, v81
    v_exp_f32 v84, v84
    v_mfma_f32_32x32x16_bf16 v[136:151], v[52:55], v[116:119], v[136:151]
    v_exp_f32 v85, v85
    v_cvt_pk_bf16_f32 v109, v82, v83
    v_exp_f32 v86, v86
    v_exp_f32 v87, v87
    v_cvt_pk_bf16_f32 v110, v84, v85
    v_cvt_pk_bf16_f32 v111, v86, v87
    s_mov_b64 exec, s[14:15]
    buffer_load_dwordx4 v[48:51], v4, s[8:11], s13 offen
    buffer_load_dwordx4 v[52:55], v4, s[8:11], s13 offen offset:640
    s_mov_b64 exec, -1
    s_add_u32 s13, s13, 1280
    s_waitcnt lgkmcnt(0)
    v_mfma_f32_32x32x16_bf16 v[72:87], v[34:37], v[16:19], 0
    v_exp_f32 v88, v88
    v_exp_f32 v89, v89
    v_exp_f32 v90, v90
    v_exp_f32 v91, v91
    v_cvt_pk_bf16_f32 v112, v88, v89
    v_exp_f32 v92, v92
    s_waitcnt vmcnt(6)
    v_mfma_f32_32x32x16_bf16 v[120:135], v[56:59], v[104:107], v[120:135]
    v_exp_f32 v93, v93
    v_cvt_pk_bf16_f32 v113, v90, v91
    v_exp_f32 v94, v94
    v_exp_f32 v95, v95
    v_cvt_pk_bf16_f32 v114, v92, v93
    v_exp_f32 v96, v96
    v_mfma_f32_32x32x8bf16_1k v[72:87], v[38:39], v[20:21], v[72:87]
    v_exp_f32 v97, v97
    v_cvt_pk_bf16_f32 v115, v94, v95
    v_exp_f32 v98, v98
    v_exp_f32 v99, v99
    v_cvt_pk_bf16_f32 v116, v96, v97
    v_exp_f32 v100, v100
    v_mfma_f32_32x32x16_bf16 v[120:135], v[60:63], v[108:111], v[120:135]
    v_exp_f32 v101, v101
    v_cvt_pk_bf16_f32 v117, v98, v99
    v_exp_f32 v102, v102
    v_exp_f32 v103, v103
    v_cvt_pk_bf16_f32 v118, v100, v101
    v_cvt_pk_bf16_f32 v119, v102, v103
    ds_read_b128 v[28:31], v2 offset:5120
    s_mov_b64 exec, 0xffffffff
    ds_read_b64 v[32:33], v3 offset:5120
    s_mov_b64 exec, -1
    v_mfma_f32_32x32x16_bf16 v[88:103], v[34:37], v[22:25], 0
    v_exp_f32 v72, v72
    v_exp_f32 v73, v73
    v_exp_f32 v74, v74
    v_exp_f32 v75, v75
    v_cvt_pk_bf16_f32 v104, v72, v73
    v_exp_f32 v76, v76
    v_mfma_f32_32x32x16_bf16 v[136:151], v[56:59], v[112:115], v[136:151]
    v_exp_f32 v77, v77
    v_cvt_pk_bf16_f32 v105, v74, v75
    v_exp_f32 v78, v78
    v_exp_f32 v79, v79
    v_cvt_pk_bf16_f32 v106, v76, v77
    v_exp_f32 v80, v80
    v_mfma_f32_32x32x8bf16_1k v[88:103], v[38:39], v[26:27], v[88:103]
    v_exp_f32 v81, v81
    v_cvt_pk_bf16_f32 v107, v78, v79
    v_exp_f32 v82, v82
    v_exp_f32 v83, v83
    v_cvt_pk_bf16_f32 v108, v80, v81
    v_exp_f32 v84, v84
    v_mfma_f32_32x32x16_bf16 v[136:151], v[60:63], v[116:119], v[136:151]
    v_exp_f32 v85, v85
    v_cvt_pk_bf16_f32 v109, v82, v83
    v_exp_f32 v86, v86
    v_exp_f32 v87, v87
    v_cvt_pk_bf16_f32 v110, v84, v85
    v_cvt_pk_bf16_f32 v111, v86, v87
    s_mov_b64 exec, s[14:15]
    buffer_load_dwordx4 v[56:59], v4, s[8:11], s13 offen
    buffer_load_dwordx4 v[60:63], v4, s[8:11], s13 offen offset:640
    s_mov_b64 exec, -1
    s_add_u32 s13, s13, 1280
    s_waitcnt lgkmcnt(0)
    v_mfma_f32_32x32x16_bf16 v[72:87], v[28:31], v[16:19], 0
    v_exp_f32 v88, v88
    v_exp_f32 v89, v89
    v_exp_f32 v90, v90
    v_exp_f32 v91, v91
    v_cvt_pk_bf16_f32 v112, v88, v89
    v_exp_f32 v92, v92
    s_waitcnt vmcnt(6)
    v_mfma_f32_32x32x16_bf16 v[120:135], v[64:67], v[104:107], v[120:135]
    v_exp_f32 v93, v93
    v_cvt_pk_bf16_f32 v113, v90, v91
    v_exp_f32 v94, v94
    v_exp_f32 v95, v95
    v_cvt_pk_bf16_f32 v114, v92, v93
    v_exp_f32 v96, v96
    v_mfma_f32_32x32x8bf16_1k v[72:87], v[32:33], v[20:21], v[72:87]
    v_exp_f32 v97, v97
    v_cvt_pk_bf16_f32 v115, v94, v95
    v_exp_f32 v98, v98
    v_exp_f32 v99, v99
    v_cvt_pk_bf16_f32 v116, v96, v97
    v_exp_f32 v100, v100
    v_mfma_f32_32x32x16_bf16 v[120:135], v[68:71], v[108:111], v[120:135]
    v_add_u32 v2, 5120, v2
    v_add_u32 v3, 5120, v3
    v_exp_f32 v101, v101
    v_cvt_pk_bf16_f32 v117, v98, v99
    v_exp_f32 v102, v102
    v_exp_f32 v103, v103
    v_cvt_pk_bf16_f32 v118, v100, v101
    v_cvt_pk_bf16_f32 v119, v102, v103
    s_barrier
    buffer_store_dwordx4 v[152:155], v1, s[8:11], s48 offen sc1
    s_mov_b64 exec, 0xffffffff
    buffer_store_dwordx2 v[152:153], v7, s[8:11], s49 offen sc1
    s_mov_b64 exec, -1
    s_mov_b32 s12, 7
.p2align 6
K2_LOOP:
    ds_read_b128 v[34:37], v2 offset:1280
    s_mov_b64 exec, 0xffffffff
    ds_read_b64 v[38:39], v3 offset:1280
    s_mov_b64 exec, -1
    v_mfma_f32_32x32x16_bf16 v[88:103], v[28:31], v[22:25], 0
    v_exp_f32 v72, v72
    v_exp_f32 v73, v73
    v_exp_f32 v74, v74
    v_exp_f32 v75, v75
    v_cvt_pk_bf16_f32 v104, v72, v73
    v_exp_f32 v76, v76
    v_mfma_f32_32x32x16_bf16 v[136:151], v[64:67], v[112:115], v[136:151]
    v_exp_f32 v77, v77
    v_cvt_pk_bf16_f32 v105, v74, v75
    v_exp_f32 v78, v78
    v_exp_f32 v79, v79
    v_cvt_pk_bf16_f32 v106, v76, v77
    v_exp_f32 v80, v80
    v_mfma_f32_32x32x8bf16_1k v[88:103], v[32:33], v[26:27], v[88:103]
    v_exp_f32 v81, v81
    v_cvt_pk_bf16_f32 v107, v78, v79
    v_exp_f32 v82, v82
    v_exp_f32 v83, v83
    v_cvt_pk_bf16_f32 v108, v80, v81
    v_exp_f32 v84, v84
    v_mfma_f32_32x32x16_bf16 v[136:151], v[68:71], v[116:119], v[136:151]
    v_exp_f32 v85, v85
    v_cvt_pk_bf16_f32 v109, v82, v83
    v_exp_f32 v86, v86
    v_exp_f32 v87, v87
    v_cvt_pk_bf16_f32 v110, v84, v85
    v_cvt_pk_bf16_f32 v111, v86, v87
    s_mov_b64 exec, s[14:15]
    buffer_load_dwordx4 v[64:67], v4, s[8:11], s13 offen
    buffer_load_dwordx4 v[68:71], v4, s[8:11], s13 offen offset:640
    s_mov_b64 exec, -1
    s_add_u32 s13, s13, 1280
    s_waitcnt lgkmcnt(0)
    v_mfma_f32_32x32x16_bf16 v[72:87], v[34:37], v[16:19], 0
    v_exp_f32 v88, v88
    v_exp_f32 v89, v89
    v_exp_f32 v90, v90
    v_exp_f32 v91, v91
    v_cvt_pk_bf16_f32 v112, v88, v89
    v_exp_f32 v92, v92
    s_waitcnt vmcnt(6)
    v_mfma_f32_32x32x16_bf16 v[120:135], v[40:43], v[104:107], v[120:135]
    v_exp_f32 v93, v93
    v_cvt_pk_bf16_f32 v113, v90, v91
    v_exp_f32 v94, v94
    v_exp_f32 v95, v95
    v_cvt_pk_bf16_f32 v114, v92, v93
    v_exp_f32 v96, v96
    v_mfma_f32_32x32x8bf16_1k v[72:87], v[38:39], v[20:21], v[72:87]
    v_exp_f32 v97, v97
    v_cvt_pk_bf16_f32 v115, v94, v95
    v_exp_f32 v98, v98
    v_exp_f32 v99, v99
    v_cvt_pk_bf16_f32 v116, v96, v97
    v_exp_f32 v100, v100
    v_mfma_f32_32x32x16_bf16 v[120:135], v[44:47], v[108:111], v[120:135]
    v_exp_f32 v101, v101
    v_cvt_pk_bf16_f32 v117, v98, v99
    v_exp_f32 v102, v102
    v_exp_f32 v103, v103
    v_cvt_pk_bf16_f32 v118, v100, v101
    v_cvt_pk_bf16_f32 v119, v102, v103
    ds_read_b128 v[28:31], v2 offset:2560
    s_mov_b64 exec, 0xffffffff
    ds_read_b64 v[32:33], v3 offset:2560
    s_mov_b64 exec, -1
    v_mfma_f32_32x32x16_bf16 v[88:103], v[34:37], v[22:25], 0
    v_exp_f32 v72, v72
    v_exp_f32 v73, v73
    v_exp_f32 v74, v74
    v_exp_f32 v75, v75
    v_cvt_pk_bf16_f32 v104, v72, v73
    v_exp_f32 v76, v76
    v_mfma_f32_32x32x16_bf16 v[136:151], v[40:43], v[112:115], v[136:151]
    v_exp_f32 v77, v77
    v_cvt_pk_bf16_f32 v105, v74, v75
    v_exp_f32 v78, v78
    v_exp_f32 v79, v79
    v_cvt_pk_bf16_f32 v106, v76, v77
    v_exp_f32 v80, v80
    v_mfma_f32_32x32x8bf16_1k v[88:103], v[38:39], v[26:27], v[88:103]
    v_exp_f32 v81, v81
    v_cvt_pk_bf16_f32 v107, v78, v79
    v_exp_f32 v82, v82
    v_exp_f32 v83, v83
    v_cvt_pk_bf16_f32 v108, v80, v81
    v_exp_f32 v84, v84
    v_mfma_f32_32x32x16_bf16 v[136:151], v[44:47], v[116:119], v[136:151]
    v_exp_f32 v85, v85
    v_cvt_pk_bf16_f32 v109, v82, v83
    v_exp_f32 v86, v86
    v_exp_f32 v87, v87
    v_cvt_pk_bf16_f32 v110, v84, v85
    v_cvt_pk_bf16_f32 v111, v86, v87
    s_mov_b64 exec, s[14:15]
    buffer_load_dwordx4 v[40:43], v4, s[8:11], s13 offen
    buffer_load_dwordx4 v[44:47], v4, s[8:11], s13 offen offset:640
    s_mov_b64 exec, -1
    s_add_u32 s13, s13, 1280
    s_waitcnt lgkmcnt(0)
    v_mfma_f32_32x32x16_bf16 v[72:87], v[28:31], v[16:19], 0
    v_exp_f32 v88, v88
    v_exp_f32 v89, v89
    v_exp_f32 v90, v90
    v_exp_f32 v91, v91
    v_cvt_pk_bf16_f32 v112, v88, v89
    v_exp_f32 v92, v92
    s_waitcnt vmcnt(6)
    v_mfma_f32_32x32x16_bf16 v[120:135], v[48:51], v[104:107], v[120:135]
    v_exp_f32 v93, v93
    v_cvt_pk_bf16_f32 v113, v90, v91
    v_exp_f32 v94, v94
    v_exp_f32 v95, v95
    v_cvt_pk_bf16_f32 v114, v92, v93
    v_exp_f32 v96, v96
    v_mfma_f32_32x32x8bf16_1k v[72:87], v[32:33], v[20:21], v[72:87]
    v_exp_f32 v97, v97
    v_cvt_pk_bf16_f32 v115, v94, v95
    v_exp_f32 v98, v98
    v_exp_f32 v99, v99
    v_cvt_pk_bf16_f32 v116, v96, v97
    v_exp_f32 v100, v100
    v_mfma_f32_32x32x16_bf16 v[120:135], v[52:55], v[108:111], v[120:135]
    v_exp_f32 v101, v101
    v_cvt_pk_bf16_f32 v117, v98, v99
    v_exp_f32 v102, v102
    v_exp_f32 v103, v103
    v_cvt_pk_bf16_f32 v118, v100, v101
    v_cvt_pk_bf16_f32 v119, v102, v103
    ds_read_b128 v[34:37], v2 offset:3840
    s_mov_b64 exec, 0xffffffff
    ds_read_b64 v[38:39], v3 offset:3840
    s_mov_b64 exec, -1
    v_mfma_f32_32x32x16_bf16 v[88:103], v[28:31], v[22:25], 0
    v_exp_f32 v72, v72
    v_exp_f32 v73, v73
    v_exp_f32 v74, v74
    v_exp_f32 v75, v75
    v_cvt_pk_bf16_f32 v104, v72, v73
    v_exp_f32 v76, v76
    v_mfma_f32_32x32x16_bf16 v[136:151], v[48:51], v[112:115], v[136:151]
    v_exp_f32 v77, v77
    v_cvt_pk_bf16_f32 v105, v74, v75
    v_exp_f32 v78, v78
    v_exp_f32 v79, v79
    v_cvt_pk_bf16_f32 v106, v76, v77
    v_exp_f32 v80, v80
    v_mfma_f32_32x32x8bf16_1k v[88:103], v[32:33], v[26:27], v[88:103]
    v_exp_f32 v81, v81
    v_cvt_pk_bf16_f32 v107, v78, v79
    v_exp_f32 v82, v82
    v_exp_f32 v83, v83
    v_cvt_pk_bf16_f32 v108, v80, v81
    v_exp_f32 v84, v84
    v_mfma_f32_32x32x16_bf16 v[136:151], v[52:55], v[116:119], v[136:151]
    v_exp_f32 v85, v85
    v_cvt_pk_bf16_f32 v109, v82, v83
    v_exp_f32 v86, v86
    v_exp_f32 v87, v87
    v_cvt_pk_bf16_f32 v110, v84, v85
    v_cvt_pk_bf16_f32 v111, v86, v87
    s_mov_b64 exec, s[14:15]
    buffer_load_dwordx4 v[48:51], v4, s[8:11], s13 offen
    buffer_load_dwordx4 v[52:55], v4, s[8:11], s13 offen offset:640
    s_mov_b64 exec, -1
    s_add_u32 s13, s13, 1280
    s_waitcnt lgkmcnt(0)
    v_mfma_f32_32x32x16_bf16 v[72:87], v[34:37], v[16:19], 0
    v_exp_f32 v88, v88
    v_exp_f32 v89, v89
    v_exp_f32 v90, v90
    v_exp_f32 v91, v91
    v_cvt_pk_bf16_f32 v112, v88, v89
    v_exp_f32 v92, v92
    s_waitcnt vmcnt(6)
    v_mfma_f32_32x32x16_bf16 v[120:135], v[56:59], v[104:107], v[120:135]
    v_exp_f32 v93, v93
    v_cvt_pk_bf16_f32 v113, v90, v91
    v_exp_f32 v94, v94
    v_exp_f32 v95, v95
    v_cvt_pk_bf16_f32 v114, v92, v93
    v_exp_f32 v96, v96
    v_mfma_f32_32x32x8bf16_1k v[72:87], v[38:39], v[20:21], v[72:87]
    v_exp_f32 v97, v97
    v_cvt_pk_bf16_f32 v115, v94, v95
    v_exp_f32 v98, v98
    v_exp_f32 v99, v99
    v_cvt_pk_bf16_f32 v116, v96, v97
    v_exp_f32 v100, v100
    v_mfma_f32_32x32x16_bf16 v[120:135], v[60:63], v[108:111], v[120:135]
    v_exp_f32 v101, v101
    v_cvt_pk_bf16_f32 v117, v98, v99
    v_exp_f32 v102, v102
    v_exp_f32 v103, v103
    v_cvt_pk_bf16_f32 v118, v100, v101
    v_cvt_pk_bf16_f32 v119, v102, v103
    ds_read_b128 v[28:31], v2 offset:5120
    s_mov_b64 exec, 0xffffffff
    ds_read_b64 v[32:33], v3 offset:5120
    s_mov_b64 exec, -1
    v_mfma_f32_32x32x16_bf16 v[88:103], v[34:37], v[22:25], 0
    v_exp_f32 v72, v72
    v_exp_f32 v73, v73
    v_exp_f32 v74, v74
    v_exp_f32 v75, v75
    v_cvt_pk_bf16_f32 v104, v72, v73
    v_exp_f32 v76, v76
    v_mfma_f32_32x32x16_bf16 v[136:151], v[56:59], v[112:115], v[136:151]
    v_exp_f32 v77, v77
    v_cvt_pk_bf16_f32 v105, v74, v75
    v_exp_f32 v78, v78
    v_exp_f32 v79, v79
    v_cvt_pk_bf16_f32 v106, v76, v77
    v_exp_f32 v80, v80
    v_mfma_f32_32x32x8bf16_1k v[88:103], v[38:39], v[26:27], v[88:103]
    v_exp_f32 v81, v81
    v_cvt_pk_bf16_f32 v107, v78, v79
    v_exp_f32 v82, v82
    v_exp_f32 v83, v83
    v_cvt_pk_bf16_f32 v108, v80, v81
    v_exp_f32 v84, v84
    v_mfma_f32_32x32x16_bf16 v[136:151], v[60:63], v[116:119], v[136:151]
    v_exp_f32 v85, v85
    v_cvt_pk_bf16_f32 v109, v82, v83
    v_exp_f32 v86, v86
    v_exp_f32 v87, v87
    v_cvt_pk_bf16_f32 v110, v84, v85
    v_cvt_pk_bf16_f32 v111, v86, v87
    s_mov_b64 exec, s[14:15]
    buffer_load_dwordx4 v[56:59], v4, s[8:11], s13 offen
    buffer_load_dwordx4 v[60:63], v4, s[8:11], s13 offen offset:640
    s_mov_b64 exec, -1
    s_add_u32 s13, s13, 1280
    s_waitcnt lgkmcnt(0)
    v_mfma_f32_32x32x16_bf16 v[72:87], v[28:31], v[16:19], 0
    v_exp_f32 v88, v88
    v_exp_f32 v89, v89
    v_exp_f32 v90, v90
    v_exp_f32 v91, v91
    v_cvt_pk_bf16_f32 v112, v88, v89
    v_exp_f32 v92, v92
    s_waitcnt vmcnt(6)
    v_mfma_f32_32x32x16_bf16 v[120:135], v[64:67], v[104:107], v[120:135]
    v_exp_f32 v93, v93
    v_cvt_pk_bf16_f32 v113, v90, v91
    v_exp_f32 v94, v94
    v_exp_f32 v95, v95
    v_cvt_pk_bf16_f32 v114, v92, v93
    v_exp_f32 v96, v96
    v_mfma_f32_32x32x8bf16_1k v[72:87], v[32:33], v[20:21], v[72:87]
    v_exp_f32 v97, v97
    v_cvt_pk_bf16_f32 v115, v94, v95
    v_exp_f32 v98, v98
    v_exp_f32 v99, v99
    v_cvt_pk_bf16_f32 v116, v96, v97
    v_exp_f32 v100, v100
    v_mfma_f32_32x32x16_bf16 v[120:135], v[68:71], v[108:111], v[120:135]
    v_add_u32 v2, 5120, v2
    v_add_u32 v3, 5120, v3
    v_exp_f32 v101, v101
    v_cvt_pk_bf16_f32 v117, v98, v99
    v_exp_f32 v102, v102
    v_exp_f32 v103, v103
    v_cvt_pk_bf16_f32 v118, v100, v101
    v_cvt_pk_bf16_f32 v119, v102, v103
    s_cmp_lg_u32 s12, 7
    s_cbranch_scc1 K2_NOBAR
    s_barrier
K2_NOBAR:
    s_sub_u32 s12, s12, 1
    s_cmp_lg_u32 s12, 0
    s_cbranch_scc1 K2_LOOP
    v_mfma_f32_32x32x16_bf16 v[136:151], v[64:67], v[112:115], v[136:151]
    v_mfma_f32_32x32x16_bf16 v[136:151], v[68:71], v[116:119], v[136:151]
    v_mov_b32 v8, 0
    v_mov_b32 v9, 0
    v_mov_b32 v10, 0
    v_mov_b32 v11, 0
    v_pk_fma_f32 v[8:9], v[120:121], v[10:11], v[8:9]
    v_pk_fma_f32 v[8:9], v[122:123], v[10:11], v[8:9]
    v_pk_fma_f32 v[8:9], v[124:125], v[10:11], v[8:9]
    v_pk_fma_f32 v[8:9], v[126:127], v[10:11], v[8:9]
    v_pk_fma_f32 v[8:9], v[128:129], v[10:11], v[8:9]
    v_pk_fma_f32 v[8:9], v[130:131], v[10:11], v[8:9]
    s_nop 1
    v_pk_fma_f32 v[8:9], v[136:137], v[10:11], v[8:9]
    v_pk_fma_f32 v[8:9], v[138:139], v[10:11], v[8:9]
    v_pk_fma_f32 v[8:9], v[140:141], v[10:11], v[8:9]
    v_pk_fma_f32 v[8:9], v[142:143], v[10:11], v[8:9]
    v_pk_fma_f32 v[8:9], v[144:145], v[10:11], v[8:9]
    v_pk_fma_f32 v[8:9], v[146:147], v[10:11], v[8:9]
    v_add_f32 v8, v8, v9
    v_max_f32 v12, v132, v148
    v_min_f32 v13, v132, v148
    v_add_f32 v14, v132, v148
    v_add_f32 v8, v8, v14
    s_mov_b32 s28, 1602224128
    s_mov_b32 s29, 528482304
    v_cmp_u_f32 s[30:31], v8, v8
    v_cmp_lt_f32 s[32:33], s28, v12
    v_cmp_gt_f32 s[34:35], s29, v13
    s_or_b64 s[30:31], s[30:31], s[32:33]
    s_or_b64 s[30:31], s[30:31], s[34:35]
    s_cmp_lg_u64 s[30:31], 0
    s_cbranch_scc1 K2_FALLBACK
K2_COMBINE:
    v_lshl_add_u32 v8, v0, 4, s50
    v_lshl_add_u32 v9, v0, 4, s51
    v_lshl_add_u32 v10, v0, 4, s52
    s_waitcnt vmcnt(0)
    s_barrier
    s_cmp_eq_u32 s20, 0
    s_cbranch_scc1 K2_SENDY
    v_swap_b32 v120, v136
    v_swap_b32 v121, v137
    v_swap_b32 v122, v138
    v_swap_b32 v123, v139
    v_swap_b32 v124, v140
    v_swap_b32 v125, v141
    v_swap_b32 v126, v142
    v_swap_b32 v127, v143
    v_swap_b32 v128, v144
    v_swap_b32 v129, v145
    v_swap_b32 v130, v146
    v_swap_b32 v131, v147
    v_swap_b32 v132, v148
    v_swap_b32 v133, v149
    v_swap_b32 v5, v6
K2_SENDY:
    v_mov_b32 v149, v6
    ds_write_b128 v8, v[136:139] offset:0
    ds_write_b128 v8, v[140:143] offset:1024
    ds_write_b128 v8, v[144:147] offset:2048
    ds_write_b128 v8, v[148:151] offset:3072
    s_waitcnt lgkmcnt(0)
    s_barrier
    ds_read_b128 v[152:155], v9 offset:0
    ds_read_b128 v[156:159], v9 offset:1024
    ds_read_b128 v[160:163], v9 offset:2048
    ds_read_b128 v[164:167], v9 offset:3072
    s_waitcnt lgkmcnt(0)
    v_min_f32 v12, v5, v165
    v_sub_f32 v13, v12, v5
    v_sub_f32 v14, v12, v165
    v_exp_f32 v13, v13
    v_exp_f32 v14, v14
    v_mul_f32 v12, v13, v132
    v_fmac_f32 v12, v14, v164
    v_rcp_f32 v12, v12
    s_nop 0
    v_mul_f32 v13, v13, v12
    v_mul_f32 v14, v14, v12
    v_mul_f32 v120, v13, v120
    v_mul_f32 v121, v13, v121
    v_mul_f32 v122, v13, v122
    v_mul_f32 v123, v13, v123
    v_mul_f32 v124, v13, v124
    v_mul_f32 v125, v13, v125
    v_mul_f32 v126, v13, v126
    v_mul_f32 v127, v13, v127
    v_mul_f32 v128, v13, v128
    v_mul_f32 v129, v13, v129
    v_mul_f32 v130, v13, v130
    v_mul_f32 v131, v13, v131
    v_fmac_f32 v120, v14, v152
    v_fmac_f32 v121, v14, v153
    v_fmac_f32 v122, v14, v154
    v_fmac_f32 v123, v14, v155
    v_fmac_f32 v124, v14, v156
    v_fmac_f32 v125, v14, v157
    v_fmac_f32 v126, v14, v158
    v_fmac_f32 v127, v14, v159
    v_fmac_f32 v128, v14, v160
    v_fmac_f32 v129, v14, v161
    v_fmac_f32 v130, v14, v162
    v_fmac_f32 v131, v14, v163
    v_cvt_pk_bf16_f32 v136, v120, v121
    v_cvt_pk_bf16_f32 v137, v122, v123
    v_cvt_pk_bf16_f32 v138, v124, v125
    v_cvt_pk_bf16_f32 v139, v126, v127
    v_cvt_pk_bf16_f32 v140, v128, v129
    v_cvt_pk_bf16_f32 v141, v130, v131
    buffer_store_dwordx4 v[136:139], v1, s[8:11], s48 offen sc1
    s_mov_b64 exec, 0xffffffff
    buffer_store_dwordx2 v[140:141], v7, s[8:11], s49 offen sc1
    s_mov_b64 exec, -1
    s_cmp_eq_u32 s19, 3
    s_cbranch_scc1 K2_NOA1
    ds_read_b128 v[16:19], v10 offset:0
    ds_read_b128 v[20:23], v10 offset:1024
    ds_read_b128 v[24:27], v10 offset:2048
    ds_read_b128 v[28:31], v10 offset:3072
    ds_read_b128 v[32:35], v10 offset:4096
    ds_read_b128 v[36:39], v10 offset:5120
    ds_read_b128 v[40:43], v10 offset:6144
    ds_read_b128 v[44:47], v10 offset:7168
    ds_read_b128 v[48:51], v10 offset:8192
    ds_read_b128 v[52:55], v10 offset:9216
    ds_read_b128 v[56:59], v10 offset:10240
    ds_read_b128 v[60:63], v10 offset:11264
    ds_read_b128 v[64:67], v10 offset:12288
    ds_read_b128 v[68:71], v10 offset:13312
    ds_read_b128 v[72:75], v10 offset:14336
    ds_read_b128 v[76:79], v10 offset:15360
    ds_read_b128 v[80:83], v10 offset:16384
    ds_read_b128 v[84:87], v10 offset:17408
    ds_read_b128 v[88:91], v10 offset:18432
    ds_read_b128 v[92:95], v10 offset:19456
    ds_read_b128 v[96:99], v10 offset:20480
    ds_read_b128 v[100:103], v10 offset:21504
    ds_read_b128 v[104:107], v10 offset:22528
    ds_read_b128 v[108:111], v10 offset:23552
    ds_read_b128 v[112:115], v10 offset:24576
K2_NOA1:
    v_lshrrev_b32 v11, 4, v0
    v_add_u32 v11, s42, v11
    v_and_b32 v12, 15, v0
    v_lshlrev_b32 v2, 9, v11
    v_lshl_add_u32 v2, v12, 4, v2
    v_mul_u32_u24 v13, 205, v11
    v_lshrrev_b32 v13, 11, v13
    v_mul_u32_u24 v14, 10, v13
    v_sub_u32 v14, v11, v14
    v_lshlrev_b32 v3, 10, v14
    v_lshl_add_u32 v3, v13, 5, v3
    v_lshrrev_b32 v11, 2, v12
    v_lshl_add_u32 v3, v11, 7, v3
    v_and_b32 v11, 3, v0
    v_lshl_add_u32 v3, v11, 3, v3
    v_add_u32 v3, 81920, v3
    v_lshl_add_u32 v13, v13, 4, v12
    v_mul_u32_u24 v4, 1280, v13
    v_lshl_add_u32 v4, v14, 4, v4
    v_lshlrev_b32 v5, 2, v13
    v_lshlrev_b32 v7, 4, v0
    v_add_u32 v6, s54, v7
    v_lshrrev_b32 v1, 4, v0
    v_and_b32 v8, 15, v0
    v_lshlrev_b32 v8, 3, v8
    v_lshl_add_u32 v1, v1, 8, v8
    buffer_load_dword v5, v5, s[8:11], s43 offen
    s_mov_b32 s12, 0x1000
    s_waitcnt lgkmcnt(0)
    s_barrier
    s_add_u32 s25, s53, 0
    buffer_load_dwordx4 v[116:119], v7, s[8:11], s25 offen offset:0 sc1
    s_add_u32 s25, s53, 4096
    buffer_load_dwordx4 v[120:123], v7, s[8:11], s25 offen offset:0 sc1
    s_add_u32 s25, s53, 8192
    buffer_load_dwordx4 v[124:127], v7, s[8:11], s25 offen offset:0 sc1
    s_add_u32 s25, s53, 12288
    buffer_load_dwordx4 v[128:131], v7, s[8:11], s25 offen offset:0 sc1
    s_add_u32 s25, s53, 16384
    buffer_load_dwordx2 v[132:133], v1, s[8:11], s25 offen offset:0 sc1
    buffer_load_dwordx2 v[134:135], v1, s[8:11], s25 offen offset:128 sc1
    s_add_u32 s25, s53, 0
    buffer_load_dwordx4 v[136:139], v7, s[8:11], s25 offen offset:1024 sc1
    s_add_u32 s25, s53, 4096
    buffer_load_dwordx4 v[140:143], v7, s[8:11], s25 offen offset:1024 sc1
    s_add_u32 s25, s53, 8192
    buffer_load_dwordx4 v[144:147], v7, s[8:11], s25 offen offset:1024 sc1
    s_add_u32 s25, s53, 12288
    buffer_load_dwordx4 v[148:151], v7, s[8:11], s25 offen offset:1024 sc1
    s_add_u32 s25, s53, 16384
    buffer_load_dwordx2 v[152:153], v1, s[8:11], s25 offen offset:1024 sc1
    buffer_load_dwordx2 v[154:155], v1, s[8:11], s25 offen offset:1152 sc1
    s_cmp_lg_u32 s19, 3
    s_cbranch_scc1 K2_MM0
    ds_read_b128 v[16:19], v10 offset:0
    ds_read_b128 v[20:23], v10 offset:1024
    ds_read_b128 v[24:27], v10 offset:2048
    ds_read_b128 v[28:31], v10 offset:3072
    ds_read_b128 v[32:35], v10 offset:4096
    ds_read_b128 v[36:39], v10 offset:5120
    ds_read_b128 v[40:43], v10 offset:6144
    ds_read_b128 v[44:47], v10 offset:7168
    ds_read_b128 v[48:51], v10 offset:8192
    ds_read_b128 v[52:55], v10 offset:9216
    ds_read_b128 v[56:59], v10 offset:10240
    ds_read_b128 v[60:63], v10 offset:11264
    ds_read_b128 v[64:67], v10 offset:12288
    ds_read_b128 v[68:71], v10 offset:13312
    ds_read_b128 v[72:75], v10 offset:14336
    ds_read_b128 v[76:79], v10 offset:15360
    ds_read_b128 v[80:83], v10 offset:16384
    ds_read_b128 v[84:87], v10 offset:17408
    ds_read_b128 v[88:91], v10 offset:18432
    ds_read_b128 v[92:95], v10 offset:19456
    ds_read_b128 v[96:99], v10 offset:20480
    ds_read_b128 v[100:103], v10 offset:21504
    ds_read_b128 v[104:107], v10 offset:22528
    ds_read_b128 v[108:111], v10 offset:23552
    ds_read_b128 v[112:115], v10 offset:24576
    s_waitcnt lgkmcnt(0)
K2_MM0:
    s_mov_b64 s[28:29], 0
    s_waitcnt vmcnt(11)
    v_mfma_f32_16x16x32_bf16 v[156:159], v[16:19], v[116:119], 0
    v_max_u32 v0, v116, v117
    v_mfma_f32_16x16x32_bf16 v[160:163], v[20:23], v[116:119], 0
    v_max3_u32 v0, v118, v119, v0
    v_mfma_f32_16x16x32_bf16 v[164:167], v[24:27], v[116:119], 0
    v_cmp_eq_u32 vcc, -1, v0
    v_mfma_f32_16x16x32_bf16 v[8:11], v[28:31], v[116:119], 0
    s_or_b64 s[28:29], s[28:29], vcc
    v_mfma_f32_16x16x32_bf16 v[12:15], v[32:35], v[116:119], 0
    s_waitcnt vmcnt(10)
    v_mfma_f32_16x16x32_bf16 v[156:159], v[36:39], v[120:123], v[156:159]
    v_max_u32 v0, v120, v121
    v_mfma_f32_16x16x32_bf16 v[160:163], v[40:43], v[120:123], v[160:163]
    v_max3_u32 v0, v122, v123, v0
    v_mfma_f32_16x16x32_bf16 v[164:167], v[44:47], v[120:123], v[164:167]
    v_cmp_eq_u32 vcc, -1, v0
    v_mfma_f32_16x16x32_bf16 v[8:11], v[48:51], v[120:123], v[8:11]
    s_or_b64 s[28:29], s[28:29], vcc
    v_mfma_f32_16x16x32_bf16 v[12:15], v[52:55], v[120:123], v[12:15]
    s_waitcnt vmcnt(9)
    v_mfma_f32_16x16x32_bf16 v[156:159], v[56:59], v[124:127], v[156:159]
    v_max_u32 v0, v124, v125
    v_mfma_f32_16x16x32_bf16 v[160:163], v[60:63], v[124:127], v[160:163]
    v_max3_u32 v0, v126, v127, v0
    v_mfma_f32_16x16x32_bf16 v[164:167], v[64:67], v[124:127], v[164:167]
    v_cmp_eq_u32 vcc, -1, v0
    v_mfma_f32_16x16x32_bf16 v[8:11], v[68:71], v[124:127], v[8:11]
    s_or_b64 s[28:29], s[28:29], vcc
    v_mfma_f32_16x16x32_bf16 v[12:15], v[72:75], v[124:127], v[12:15]
    s_waitcnt vmcnt(8)
    v_mfma_f32_16x16x32_bf16 v[156:159], v[76:79], v[128:131], v[156:159]
    v_max_u32 v0, v128, v129
    v_mfma_f32_16x16x32_bf16 v[160:163], v[80:83], v[128:131], v[160:163]
    v_max3_u32 v0, v130, v131, v0
    v_mfma_f32_16x16x32_bf16 v[164:167], v[84:87], v[128:131], v[164:167]
    v_cmp_eq_u32 vcc, -1, v0
    v_mfma_f32_16x16x32_bf16 v[8:11], v[88:91], v[128:131], v[8:11]
    s_or_b64 s[28:29], s[28:29], vcc
    v_mfma_f32_16x16x32_bf16 v[12:15], v[92:95], v[128:131], v[12:15]
    s_waitcnt vmcnt(6)
    v_mfma_f32_16x16x32_bf16 v[156:159], v[96:99], v[132:135], v[156:159]
    v_max_u32 v0, v132, v133
    v_mfma_f32_16x16x32_bf16 v[160:163], v[100:103], v[132:135], v[160:163]
    v_max3_u32 v0, v134, v135, v0
    v_mfma_f32_16x16x32_bf16 v[164:167], v[104:107], v[132:135], v[164:167]
    v_cmp_eq_u32 vcc, -1, v0
    v_mfma_f32_16x16x32_bf16 v[8:11], v[108:111], v[132:135], v[8:11]
    s_or_b64 s[28:29], s[28:29], vcc
    v_mfma_f32_16x16x32_bf16 v[12:15], v[112:115], v[132:135], v[12:15]
    s_cmp_lg_u64 s[28:29], 0
    s_cbranch_scc1 K2_RETRY0
K2_MMD0:
K2_MM1:
    s_mov_b64 s[28:29], 0
    s_waitcnt vmcnt(5)
    v_mfma_f32_16x16x32_bf16 v[116:119], v[16:19], v[136:139], 0
    v_max_u32 v0, v136, v137
    v_mfma_f32_16x16x32_bf16 v[120:123], v[20:23], v[136:139], 0
    v_max3_u32 v0, v138, v139, v0
    v_mfma_f32_16x16x32_bf16 v[124:127], v[24:27], v[136:139], 0
    v_cmp_eq_u32 vcc, -1, v0
    v_mfma_f32_16x16x32_bf16 v[128:131], v[28:31], v[136:139], 0
    s_or_b64 s[28:29], s[28:29], vcc
    v_mfma_f32_16x16x32_bf16 v[132:135], v[32:35], v[136:139], 0
    ds_write_b128 v6, v[156:159] offset:0
    ds_write_b128 v6, v[160:163] offset:1024
    ds_write_b128 v6, v[164:167] offset:2048
    ds_write_b128 v6, v[8:11] offset:3072
    ds_write_b128 v6, v[12:15] offset:4096
    s_waitcnt vmcnt(4)
    v_mfma_f32_16x16x32_bf16 v[116:119], v[36:39], v[140:143], v[116:119]
    v_max_u32 v0, v140, v141
    v_mfma_f32_16x16x32_bf16 v[120:123], v[40:43], v[140:143], v[120:123]
    v_max3_u32 v0, v142, v143, v0
    v_mfma_f32_16x16x32_bf16 v[124:127], v[44:47], v[140:143], v[124:127]
    v_cmp_eq_u32 vcc, -1, v0
    v_mfma_f32_16x16x32_bf16 v[128:131], v[48:51], v[140:143], v[128:131]
    s_or_b64 s[28:29], s[28:29], vcc
    v_mfma_f32_16x16x32_bf16 v[132:135], v[52:55], v[140:143], v[132:135]
    s_waitcnt vmcnt(3)
    v_mfma_f32_16x16x32_bf16 v[116:119], v[56:59], v[144:147], v[116:119]
    v_max_u32 v0, v144, v145
    v_mfma_f32_16x16x32_bf16 v[120:123], v[60:63], v[144:147], v[120:123]
    v_max3_u32 v0, v146, v147, v0
    v_mfma_f32_16x16x32_bf16 v[124:127], v[64:67], v[144:147], v[124:127]
    v_cmp_eq_u32 vcc, -1, v0
    v_mfma_f32_16x16x32_bf16 v[128:131], v[68:71], v[144:147], v[128:131]
    s_or_b64 s[28:29], s[28:29], vcc
    v_mfma_f32_16x16x32_bf16 v[132:135], v[72:75], v[144:147], v[132:135]
    s_waitcnt vmcnt(2)
    v_mfma_f32_16x16x32_bf16 v[116:119], v[76:79], v[148:151], v[116:119]
    v_max_u32 v0, v148, v149
    v_mfma_f32_16x16x32_bf16 v[120:123], v[80:83], v[148:151], v[120:123]
    v_max3_u32 v0, v150, v151, v0
    v_mfma_f32_16x16x32_bf16 v[124:127], v[84:87], v[148:151], v[124:127]
    v_cmp_eq_u32 vcc, -1, v0
    v_mfma_f32_16x16x32_bf16 v[128:131], v[88:91], v[148:151], v[128:131]
    s_or_b64 s[28:29], s[28:29], vcc
    v_mfma_f32_16x16x32_bf16 v[132:135], v[92:95], v[148:151], v[132:135]
    s_waitcnt vmcnt(0)
    v_mfma_f32_16x16x32_bf16 v[116:119], v[96:99], v[152:155], v[116:119]
    v_max_u32 v0, v152, v153
    v_mfma_f32_16x16x32_bf16 v[120:123], v[100:103], v[152:155], v[120:123]
    v_max3_u32 v0, v154, v155, v0
    v_mfma_f32_16x16x32_bf16 v[124:127], v[104:107], v[152:155], v[124:127]
    v_cmp_eq_u32 vcc, -1, v0
    v_mfma_f32_16x16x32_bf16 v[128:131], v[108:111], v[152:155], v[128:131]
    s_or_b64 s[28:29], s[28:29], vcc
    v_mfma_f32_16x16x32_bf16 v[132:135], v[112:115], v[152:155], v[132:135]
    s_cmp_lg_u64 s[28:29], 0
    s_cbranch_scc1 K2_RETRY1
K2_MMD1:
    ds_write_b128 v6, v[116:119] offset:5120
    ds_write_b128 v6, v[120:123] offset:6144
    ds_write_b128 v6, v[124:127] offset:7168
    s_nop 0
    ds_write_b128 v6, v[128:131] offset:8192
    s_nop 0
    ds_write_b128 v6, v[132:135] offset:9216
    s_branch K2_FINAL
K2_RETRY0:
    s_sub_u32 s12, s12, 1
    s_cmp_eq_u32 s12, 0
    s_cbranch_scc1 K2_MMD0
    s_sleep 4
    s_add_u32 s25, s53, 0
    buffer_load_dwordx4 v[116:119], v7, s[8:11], s25 offen offset:0 sc1
    s_add_u32 s25, s53, 4096
    buffer_load_dwordx4 v[120:123], v7, s[8:11], s25 offen offset:0 sc1
    s_add_u32 s25, s53, 8192
    buffer_load_dwordx4 v[124:127], v7, s[8:11], s25 offen offset:0 sc1
    s_add_u32 s25, s53, 12288
    buffer_load_dwordx4 v[128:131], v7, s[8:11], s25 offen offset:0 sc1
    s_add_u32 s25, s53, 16384
    buffer_load_dwordx2 v[132:133], v1, s[8:11], s25 offen offset:0 sc1
    buffer_load_dwordx2 v[134:135], v1, s[8:11], s25 offen offset:128 sc1
    s_waitcnt vmcnt(0)
    s_branch K2_MM0
K2_RETRY1:
    s_sub_u32 s12, s12, 1
    s_cmp_eq_u32 s12, 0
    s_cbranch_scc1 K2_MMD1
    s_sleep 4
    s_add_u32 s25, s53, 0
    buffer_load_dwordx4 v[136:139], v7, s[8:11], s25 offen offset:1024 sc1
    s_add_u32 s25, s53, 4096
    buffer_load_dwordx4 v[140:143], v7, s[8:11], s25 offen offset:1024 sc1
    s_add_u32 s25, s53, 8192
    buffer_load_dwordx4 v[144:147], v7, s[8:11], s25 offen offset:1024 sc1
    s_add_u32 s25, s53, 12288
    buffer_load_dwordx4 v[148:151], v7, s[8:11], s25 offen offset:1024 sc1
    s_add_u32 s25, s53, 16384
    buffer_load_dwordx2 v[152:153], v1, s[8:11], s25 offen offset:1024 sc1
    buffer_load_dwordx2 v[154:155], v1, s[8:11], s25 offen offset:1152 sc1
    s_waitcnt vmcnt(0)
    s_branch K2_MM1
K2_FALLBACK:
    s_waitcnt vmcnt(0)
    v_subrev_u32 v2, 40960, v2
    v_subrev_u32 v3, 40960, v3
    s_sub_u32 s13, s13, 44800
    v_mov_b32 v120, 0
    v_mov_b32 v121, 0
    v_mov_b32 v122, 0
    v_mov_b32 v123, 0
    v_mov_b32 v124, 0
    v_mov_b32 v125, 0
    v_mov_b32 v126, 0
    v_mov_b32 v127, 0
    v_mov_b32 v128, 0
    v_mov_b32 v129, 0
    v_mov_b32 v130, 0
    v_mov_b32 v131, 0
    v_mov_b32 v132, 0
    v_mov_b32 v133, 0
    v_mov_b32 v134, 0
    v_mov_b32 v135, 0
    v_mov_b32 v136, 0
    v_mov_b32 v137, 0
    v_mov_b32 v138, 0
    v_mov_b32 v139, 0
    v_mov_b32 v140, 0
    v_mov_b32 v141, 0
    v_mov_b32 v142, 0
    v_mov_b32 v143, 0
    v_mov_b32 v144, 0
    v_mov_b32 v145, 0
    v_mov_b32 v146, 0
    v_mov_b32 v147, 0
    v_mov_b32 v148, 0
    v_mov_b32 v149, 0
    v_mov_b32 v150, 0
    v_mov_b32 v151, 0
    v_mov_b32 v152, 4284592614
    v_mov_b32 v153, 4284592614
    s_mov_b32 s12, 32
K2_FB_LOOP:
    ds_read_b128 v[28:31], v2 offset:0
    s_mov_b64 exec, 0xffffffff
    ds_read_b64 v[32:33], v3 offset:0
    s_mov_b64 exec, -1
    s_mov_b64 exec, s[14:15]
    buffer_load_dwordx4 v[40:43], v4, s[8:11], s13 offen
    buffer_load_dwordx4 v[44:47], v4, s[8:11], s13 offen offset:640
    s_mov_b64 exec, -1
    s_add_u32 s13, s13, 1280
    s_waitcnt lgkmcnt(0)
    v_mfma_f32_32x32x16_bf16 v[72:87], v[28:31], v[16:19], 0
    v_mfma_f32_32x32x8bf16_1k v[72:87], v[32:33], v[20:21], v[72:87]
    s_nop 11
    v_max3_f32 v155, v72, v73, v74
    v_max3_f32 v155, v155, v75, v76
    v_max3_f32 v155, v155, v77, v78
    v_max3_f32 v155, v155, v79, v80
    v_max3_f32 v155, v155, v81, v82
    v_max3_f32 v155, v155, v83, v84
    v_max3_f32 v155, v155, v85, v86
    v_max_f32 v155, v155, v87
    v_mov_b32 v8, v155
    s_nop 1
    v_permlane32_swap_b32 v155, v8
    v_max_f32 v155, v155, v8
    v_max_f32 v155, v155, v152
    v_sub_f32 v154, v152, v155
    v_exp_f32 v154, v154
    v_mov_b32 v152, v155
    v_sub_f32 v72, v72, v155
    v_sub_f32 v73, v73, v155
    v_sub_f32 v74, v74, v155
    v_sub_f32 v75, v75, v155
    v_sub_f32 v76, v76, v155
    v_sub_f32 v77, v77, v155
    v_sub_f32 v78, v78, v155
    v_sub_f32 v79, v79, v155
    v_sub_f32 v80, v80, v155
    v_sub_f32 v81, v81, v155
    v_sub_f32 v82, v82, v155
    v_sub_f32 v83, v83, v155
    v_sub_f32 v84, v84, v155
    v_sub_f32 v85, v85, v155
    v_sub_f32 v86, v86, v155
    v_sub_f32 v87, v87, v155
    v_mul_f32 v120, v154, v120
    v_mul_f32 v121, v154, v121
    v_mul_f32 v122, v154, v122
    v_mul_f32 v123, v154, v123
    v_mul_f32 v124, v154, v124
    v_mul_f32 v125, v154, v125
    v_mul_f32 v126, v154, v126
    v_mul_f32 v127, v154, v127
    v_mul_f32 v128, v154, v128
    v_mul_f32 v129, v154, v129
    v_mul_f32 v130, v154, v130
    v_mul_f32 v131, v154, v131
    v_mul_f32 v132, v154, v132
    v_mul_f32 v133, v154, v133
    v_mul_f32 v134, v154, v134
    v_mul_f32 v135, v154, v135
    v_exp_f32 v72, v72
    v_exp_f32 v73, v73
    v_exp_f32 v74, v74
    v_exp_f32 v75, v75
    v_cvt_pk_bf16_f32 v104, v72, v73
    v_exp_f32 v76, v76
    v_exp_f32 v77, v77
    v_cvt_pk_bf16_f32 v105, v74, v75
    v_exp_f32 v78, v78
    v_exp_f32 v79, v79
    v_cvt_pk_bf16_f32 v106, v76, v77
    v_exp_f32 v80, v80
    v_exp_f32 v81, v81
    v_cvt_pk_bf16_f32 v107, v78, v79
    v_exp_f32 v82, v82
    v_exp_f32 v83, v83
    v_cvt_pk_bf16_f32 v108, v80, v81
    v_exp_f32 v84, v84
    v_exp_f32 v85, v85
    v_cvt_pk_bf16_f32 v109, v82, v83
    v_exp_f32 v86, v86
    v_exp_f32 v87, v87
    v_cvt_pk_bf16_f32 v110, v84, v85
    v_cvt_pk_bf16_f32 v111, v86, v87
    s_waitcnt vmcnt(0)
    v_mfma_f32_32x32x16_bf16 v[120:135], v[40:43], v[104:107], v[120:135]
    v_mfma_f32_32x32x16_bf16 v[120:135], v[44:47], v[108:111], v[120:135]
    v_mfma_f32_32x32x16_bf16 v[88:103], v[28:31], v[22:25], 0
    v_mfma_f32_32x32x8bf16_1k v[88:103], v[32:33], v[26:27], v[88:103]
    s_nop 11
    v_max3_f32 v155, v88, v89, v90
    v_max3_f32 v155, v155, v91, v92
    v_max3_f32 v155, v155, v93, v94
    v_max3_f32 v155, v155, v95, v96
    v_max3_f32 v155, v155, v97, v98
    v_max3_f32 v155, v155, v99, v100
    v_max3_f32 v155, v155, v101, v102
    v_max_f32 v155, v155, v103
    v_mov_b32 v8, v155
    s_nop 1
    v_permlane32_swap_b32 v155, v8
    v_max_f32 v155, v155, v8
    v_max_f32 v155, v155, v153
    v_sub_f32 v154, v153, v155
    v_exp_f32 v154, v154
    v_mov_b32 v153, v155
    v_sub_f32 v88, v88, v155
    v_sub_f32 v89, v89, v155
    v_sub_f32 v90, v90, v155
    v_sub_f32 v91, v91, v155
    v_sub_f32 v92, v92, v155
    v_sub_f32 v93, v93, v155
    v_sub_f32 v94, v94, v155
    v_sub_f32 v95, v95, v155
    v_sub_f32 v96, v96, v155
    v_sub_f32 v97, v97, v155
    v_sub_f32 v98, v98, v155
    v_sub_f32 v99, v99, v155
    v_sub_f32 v100, v100, v155
    v_sub_f32 v101, v101, v155
    v_sub_f32 v102, v102, v155
    v_sub_f32 v103, v103, v155
    v_mul_f32 v136, v154, v136
    v_mul_f32 v137, v154, v137
    v_mul_f32 v138, v154, v138
    v_mul_f32 v139, v154, v139
    v_mul_f32 v140, v154, v140
    v_mul_f32 v141, v154, v141
    v_mul_f32 v142, v154, v142
    v_mul_f32 v143, v154, v143
    v_mul_f32 v144, v154, v144
    v_mul_f32 v145, v154, v145
    v_mul_f32 v146, v154, v146
    v_mul_f32 v147, v154, v147
    v_mul_f32 v148, v154, v148
    v_mul_f32 v149, v154, v149
    v_mul_f32 v150, v154, v150
    v_mul_f32 v151, v154, v151
    v_exp_f32 v88, v88
    v_exp_f32 v89, v89
    v_exp_f32 v90, v90
    v_exp_f32 v91, v91
    v_cvt_pk_bf16_f32 v112, v88, v89
    v_exp_f32 v92, v92
    v_exp_f32 v93, v93
    v_cvt_pk_bf16_f32 v113, v90, v91
    v_exp_f32 v94, v94
    v_exp_f32 v95, v95
    v_cvt_pk_bf16_f32 v114, v92, v93
    v_exp_f32 v96, v96
    v_exp_f32 v97, v97
    v_cvt_pk_bf16_f32 v115, v94, v95
    v_exp_f32 v98, v98
    v_exp_f32 v99, v99
    v_cvt_pk_bf16_f32 v116, v96, v97
    v_exp_f32 v100, v100
    v_exp_f32 v101, v101
    v_cvt_pk_bf16_f32 v117, v98, v99
    v_exp_f32 v102, v102
    v_exp_f32 v103, v103
    v_cvt_pk_bf16_f32 v118, v100, v101
    v_cvt_pk_bf16_f32 v119, v102, v103
    s_waitcnt vmcnt(0)
    v_mfma_f32_32x32x16_bf16 v[136:151], v[40:43], v[112:115], v[136:151]
    v_mfma_f32_32x32x16_bf16 v[136:151], v[44:47], v[116:119], v[136:151]
    v_add_u32 v2, 1280, v2
    v_add_u32 v3, 1280, v3
    s_sub_u32 s12, s12, 1
    s_cmp_lg_u32 s12, 0
    s_nop 7
    s_nop 7
    s_cbranch_scc1 K2_FB_LOOP
    v_sub_f32 v5, v5, v152
    v_sub_f32 v6, v6, v153
    s_branch K2_COMBINE
K2_CONV:
    s_sub_u32 s19, s3, 8
    s_and_b32 s31, s2, 1
    s_lshr_b32 s32, s2, 1
    s_mul_i32 s32, s32, 5
    s_mul_i32 s20, s31, 3
    s_add_u32 s20, s20, s19
    s_cmp_eq_u32 s19, 2
    s_cselect_b32 s20, 2, s20
    s_mul_i32 s33, s31, 3
    s_cmp_eq_u32 s19, 3
    s_cselect_b32 s20, s33, s20
    s_cselect_b32 s33, 0, s19
    s_add_u32 s20, s20, s32
    s_mul_i32 s21, s33, 22720
    s_add_u32 s21, s21, 81920
    s_mul_i32 s22, s20, 4112
    s_add_u32 s22, s22, 10485760
    s_lshl_b32 s23, s20, 12
    s_add_u32 s24, s23, 7864320
    s_lshl_b32 s25, s20, 7
    s_add_u32 s25, s25, 13631488
    v_lshlrev_b32 v8, 4, v0
    v_lshlrev_b32 v9, 6, v0
    s_add_u32 s27, s16, 2621440
    v_mov_b32 v12, 0
    v_mov_b32 v13, 0
    v_mov_b32 v14, 0
    v_mov_b32 v15, 0
    v_mov_b32 v10, 163832
    ds_write_b64 v10, v[12:13]
    s_waitcnt lgkmcnt(0)
    s_mov_b32 s8, s4
    s_and_b32 s9, s5, 0xffff
    s_mov_b32 s10, 22020096
    s_mov_b32 s11, 0x20000
    s_lshr_b32 s28, s19, 1
    s_mul_i32 s28, s28, 40960
    s_and_b32 s29, s19, 1
    s_lshl_b32 s29, s29, 12
    s_add_u32 s28, s28, s29
    s_add_u32 m0, s28, 8192
    s_add_u32 s29, s28, s27
    s_add_u32 s29, s29, 8192
    buffer_load_dwordx4 v8, s[8:11], s29 offen offset:0 lds
    buffer_load_dwordx4 v8, s[8:11], s29 offen offset:1024 lds
    buffer_load_dwordx4 v8, s[8:11], s29 offen offset:2048 lds
    buffer_load_dwordx4 v8, s[8:11], s29 offen offset:3072 lds
    s_barrier
    s_mul_i32 s28, s19, 6144
    s_add_u32 s28, s28, 16384
    s_add_u32 m0, s28, 0
    s_add_u32 s29, s28, s27
    s_add_u32 s29, s29, 0
    buffer_load_dwordx4 v8, s[8:11], s29 offen offset:0 lds
    buffer_load_dwordx4 v8, s[8:11], s29 offen offset:1024 lds
    buffer_load_dwordx4 v8, s[8:11], s29 offen offset:2048 lds
    s_add_u32 m0, s28, 40960
    s_add_u32 s29, s28, s27
    s_add_u32 s29, s29, 40960
    buffer_load_dwordx4 v8, s[8:11], s29 offen offset:0 lds
    buffer_load_dwordx4 v8, s[8:11], s29 offen offset:1024 lds
    buffer_load_dwordx4 v8, s[8:11], s29 offen offset:2048 lds
    s_add_u32 m0, s28, 3072
    s_add_u32 s29, s28, s27
    s_add_u32 s29, s29, 3072
    buffer_load_dwordx4 v8, s[8:11], s29 offen offset:0 lds
    buffer_load_dwordx4 v8, s[8:11], s29 offen offset:1024 lds
    buffer_load_dwordx4 v8, s[8:11], s29 offen offset:2048 lds
    s_add_u32 m0, s28, 44032
    s_add_u32 s29, s28, s27
    s_add_u32 s29, s29, 44032
    buffer_load_dwordx4 v8, s[8:11], s29 offen offset:0 lds
    buffer_load_dwordx4 v8, s[8:11], s29 offen offset:1024 lds
    buffer_load_dwordx4 v8, s[8:11], s29 offen offset:2048 lds
    s_cmp_eq_u32 s19, 3
    s_cbranch_scc1 K2_NOSLOT
    s_add_u32 m0, s21, 17136
    s_nop 0
    buffer_load_dwordx4 v9, s[8:11], s24 offen offset:0 lds
    s_add_u32 m0, s21, 18640
    s_nop 0
    buffer_load_dwordx4 v9, s[8:11], s24 offen offset:16 lds
    s_add_u32 m0, s21, 20144
    s_nop 0
    buffer_load_dwordx4 v9, s[8:11], s24 offen offset:32 lds
    s_add_u32 m0, s21, 21648
    s_nop 0
    buffer_load_dwordx4 v9, s[8:11], s24 offen offset:48 lds
    s_add_u32 m0, s21, 0
    s_add_u32 s26, s22, 0
    buffer_load_dwordx4 v8, s[8:11], s26 offen offset:3072 lds
    s_add_u32 m0, s21, 4160
    s_add_u32 s26, s22, 2
    buffer_load_dwordx4 v8, s[8:11], s26 offen offset:3072 lds
    s_add_u32 m0, s21, 8320
    s_add_u32 s26, s22, 4
    buffer_load_dwordx4 v8, s[8:11], s26 offen offset:3072 lds
    s_add_u32 m0, s21, 12480
    s_add_u32 s26, s22, 6
    buffer_load_dwordx4 v8, s[8:11], s26 offen offset:3072 lds
    s_add_u32 m0, s21, 0
    s_add_u32 s26, s22, 0
    buffer_load_dwordx4 v8, s[8:11], s26 offen offset:2048 lds
    s_add_u32 m0, s21, 4160
    s_add_u32 s26, s22, 2
    buffer_load_dwordx4 v8, s[8:11], s26 offen offset:2048 lds
    s_add_u32 m0, s21, 8320
    s_add_u32 s26, s22, 4
    buffer_load_dwordx4 v8, s[8:11], s26 offen offset:2048 lds
    s_add_u32 m0, s21, 12480
    s_add_u32 s26, s22, 6
    buffer_load_dwordx4 v8, s[8:11], s26 offen offset:2048 lds
    s_add_u32 m0, s21, 0
    s_add_u32 s26, s22, 0
    buffer_load_dwordx4 v8, s[8:11], s26 offen offset:1024 lds
    s_add_u32 m0, s21, 4160
    s_add_u32 s26, s22, 2
    buffer_load_dwordx4 v8, s[8:11], s26 offen offset:1024 lds
    s_add_u32 m0, s21, 8320
    s_add_u32 s26, s22, 4
    buffer_load_dwordx4 v8, s[8:11], s26 offen offset:1024 lds
    s_add_u32 m0, s21, 12480
    s_add_u32 s26, s22, 6
    buffer_load_dwordx4 v8, s[8:11], s26 offen offset:1024 lds
    s_add_u32 m0, s21, 0
    s_add_u32 s26, s22, 0
    buffer_load_dwordx4 v8, s[8:11], s26 offen offset:0 lds
    s_add_u32 m0, s21, 4160
    s_add_u32 s26, s22, 2
    buffer_load_dwordx4 v8, s[8:11], s26 offen offset:0 lds
    s_add_u32 m0, s21, 8320
    s_add_u32 s26, s22, 4
    buffer_load_dwordx4 v8, s[8:11], s26 offen offset:0 lds
    s_add_u32 m0, s21, 12480
    s_add_u32 s26, s22, 6
    buffer_load_dwordx4 v8, s[8:11], s26 offen offset:0 lds
    v_add_u32 v10, s21, v8
    s_mov_b64 exec, 0x7fffffff
    ds_write_b128 v10, v[12:15] offset:16640
    ds_write_b128 v10, v[12:15] offset:18160
    ds_write_b128 v10, v[12:15] offset:19680
    ds_write_b128 v10, v[12:15] offset:21200
    s_mov_b64 exec, 0xf
    ds_write_b128 v10, v[12:15] offset:4096
    ds_write_b128 v10, v[12:15] offset:8256
    ds_write_b128 v10, v[12:15] offset:12416
    ds_write_b128 v10, v[12:15] offset:16576
    s_mov_b64 exec, -1
    s_waitcnt vmcnt(32)
    s_branch K2_SLOTD
K2_NOSLOT:
    s_waitcnt vmcnt(12)
K2_SLOTD:
    s_barrier
    v_and_b32 v10, 31, v0
    v_lshrrev_b32 v11, 5, v0
    v_and_b32 v12, 3, v0
    v_sub_u32 v12, 3, v12
    v_mul_u32_u24 v5, 4160, v12
    v_lshl_add_u32 v5, v11, 4, v5
    v_bfe_u32 v12, v0, 2, 1
    v_bfe_u32 v13, v0, 3, 2
    v_lshl_add_u32 v12, v12, 2, v13
    v_sub_u32 v12, 7, v12
    v_lshl_add_u32 v5, v12, 3, v5
    v_add_u32 v5, s21, v5
    v_mul_u32_u24 v6, 1520, v11
    v_lshl_add_u32 v6, v10, 4, v6
    v_add_u32 v6, s21, v6
    v_add_u32 v2, 2048, v5
    s_mov_b32 s34, 512
    s_mov_b32 s35, 0
    s_mov_b32 s26, 0
    s_mov_b32 s12, 8
    s_mov_b32 s30, 1310720
    s_add_u32 s28, s19, s31
    s_cmp_lt_u32 s19, 2
    s_cbranch_scc1 K2_MODED
    s_cmp_eq_u32 s28, 2
    s_cbranch_scc1 K2_MODED
    s_mov_b32 s34, 0
    s_mov_b32 s30, 0
    s_cmp_eq_u32 s19, 3
    s_mov_b32 s35, 1024
    s_cselect_b32 s35, 24768, s35
    s_mov_b32 s26, 22720
    s_cselect_b32 s26, s26, -256
    s_cselect_b32 s12, 8, 4
K2_MODED:
    v_add_u32 v3, s34, v6
    v_add_u32 v5, s35, v5
    v_add_u32 v6, s26, v6
    v_lshrrev_b32 v12, 2, v10
    v_mul_u32_u24 v4, 163840, v12
    v_lshl_add_u32 v4, v11, 5, v4
    v_and_b32 v12, 1, v0
    v_lshl_add_u32 v4, v12, 6, v4
    v_bfe_u32 v12, v0, 1, 1
    v_lshl_add_u32 v4, v12, 4, v4
    v_mov_b32 v16, 0
    v_mov_b32 v17, 0
    v_mov_b32 v18, 0
    v_mov_b32 v19, 0
    v_mov_b32 v20, 0
    v_mov_b32 v21, 0
    v_mov_b32 v22, 0
    v_mov_b32 v23, 0
    v_mov_b32 v24, 0
    v_mov_b32 v25, 0
    v_mov_b32 v26, 0
    v_mov_b32 v27, 0
    v_mov_b32 v28, 0
    v_mov_b32 v29, 0
    v_mov_b32 v30, 0
    v_mov_b32 v31, 0
    v_mov_b32 v32, 0
    v_mov_b32 v33, 0
    v_mov_b32 v34, 0
    v_mov_b32 v35, 0
    v_mov_b32 v36, 0
    v_mov_b32 v37, 0
    v_mov_b32 v38, 0
    v_mov_b32 v39, 0
    v_mov_b32 v40, 0
    v_mov_b32 v41, 0
    v_mov_b32 v42, 0
    v_mov_b32 v43, 0
    v_mov_b32 v44, 0
    v_mov_b32 v45, 0
    v_mov_b32 v46, 0
    v_mov_b32 v47, 0
    s_waitcnt vmcnt(0) lgkmcnt(0)
    s_barrier
K2_WARMD:
    s_mov_b64 exec, -1
    s_cmp_lg_u32 0, 0
    s_cbranch_scc1 K2_CDONE
    ds_read_b64 v[64:65], v2 offset:1984
    ds_read_b64 v[66:67], v2 offset:1992
    ds_read_b64 v[68:69], v2 offset:2016
    ds_read_b64 v[70:71], v2 offset:2024
    ds_read_b128 v[72:75], v3 offset:17136
    ds_read_b128 v[76:79], v3 offset:20176
    ds_read_b64 v[80:81], v5 offset:1984
    ds_read_b64 v[82:83], v5 offset:1992
    ds_read_b64 v[84:85], v5 offset:2016
    ds_read_b64 v[86:87], v5 offset:2024
    ds_read_b128 v[88:91], v6 offset:17136
    ds_read_b128 v[92:95], v6 offset:20176
K2_CLOOP:
    ds_read_b64 v[96:97], v2 offset:1920
    ds_read_b64 v[98:99], v2 offset:1928
    ds_read_b64 v[100:101], v2 offset:1952
    ds_read_b64 v[102:103], v2 offset:1960
    ds_read_b128 v[104:107], v3 offset:17120
    ds_read_b128 v[108:111], v3 offset:20160
    ds_read_b64 v[112:113], v5 offset:1920
    ds_read_b64 v[114:115], v5 offset:1928
    ds_read_b64 v[116:117], v5 offset:1952
    ds_read_b64 v[118:119], v5 offset:1960
    ds_read_b128 v[120:123], v6 offset:17120
    ds_read_b128 v[124:127], v6 offset:20160
    s_waitcnt lgkmcnt(12)
    v_mfma_f32_32x32x16_bf16 v[16:31], v[64:67], v[72:75], v[16:31]
    v_mfma_f32_32x32x16_bf16 v[32:47], v[80:83], v[88:91], v[32:47]
    v_mfma_f32_32x32x16_bf16 v[16:31], v[68:71], v[76:79], v[16:31]
    v_mfma_f32_32x32x16_bf16 v[32:47], v[84:87], v[92:95], v[32:47]
    ds_read_b64 v[64:65], v2 offset:1856
    ds_read_b64 v[66:67], v2 offset:1864
    ds_read_b64 v[68:69], v2 offset:1888
    ds_read_b64 v[70:71], v2 offset:1896
    ds_read_b128 v[72:75], v3 offset:17104
    ds_read_b128 v[76:79], v3 offset:20144
    ds_read_b64 v[80:81], v5 offset:1856
    ds_read_b64 v[82:83], v5 offset:1864
    ds_read_b64 v[84:85], v5 offset:1888
    ds_read_b64 v[86:87], v5 offset:1896
    ds_read_b128 v[88:91], v6 offset:17104
    ds_read_b128 v[92:95], v6 offset:20144
    s_waitcnt lgkmcnt(12)
    v_mfma_f32_32x32x16_bf16 v[16:31], v[96:99], v[104:107], v[16:31]
    v_mfma_f32_32x32x16_bf16 v[32:47], v[112:115], v[120:123], v[32:47]
    v_mfma_f32_32x32x16_bf16 v[16:31], v[100:103], v[108:111], v[16:31]
    v_mfma_f32_32x32x16_bf16 v[32:47], v[116:119], v[124:127], v[32:47]
    ds_read_b64 v[96:97], v2 offset:1792
    ds_read_b64 v[98:99], v2 offset:1800
    ds_read_b64 v[100:101], v2 offset:1824
    ds_read_b64 v[102:103], v2 offset:1832
    ds_read_b128 v[104:107], v3 offset:17088
    ds_read_b128 v[108:111], v3 offset:20128
    ds_read_b64 v[112:113], v5 offset:1792
    ds_read_b64 v[114:115], v5 offset:1800
    ds_read_b64 v[116:117], v5 offset:1824
    ds_read_b64 v[118:119], v5 offset:1832
    ds_read_b128 v[120:123], v6 offset:17088
    ds_read_b128 v[124:127], v6 offset:20128
    s_waitcnt lgkmcnt(12)
    v_mfma_f32_32x32x16_bf16 v[16:31], v[64:67], v[72:75], v[16:31]
    v_mfma_f32_32x32x16_bf16 v[32:47], v[80:83], v[88:91], v[32:47]
    v_mfma_f32_32x32x16_bf16 v[16:31], v[68:71], v[76:79], v[16:31]
    v_mfma_f32_32x32x16_bf16 v[32:47], v[84:87], v[92:95], v[32:47]
    ds_read_b64 v[64:65], v2 offset:1728
    ds_read_b64 v[66:67], v2 offset:1736
    ds_read_b64 v[68:69], v2 offset:1760
    ds_read_b64 v[70:71], v2 offset:1768
    ds_read_b128 v[72:75], v3 offset:17072
    ds_read_b128 v[76:79], v3 offset:20112
    ds_read_b64 v[80:81], v5 offset:1728
    ds_read_b64 v[82:83], v5 offset:1736
    ds_read_b64 v[84:85], v5 offset:1760
    ds_read_b64 v[86:87], v5 offset:1768
    ds_read_b128 v[88:91], v6 offset:17072
    ds_read_b128 v[92:95], v6 offset:20112
    s_waitcnt lgkmcnt(12)
    v_mfma_f32_32x32x16_bf16 v[16:31], v[96:99], v[104:107], v[16:31]
    v_mfma_f32_32x32x16_bf16 v[32:47], v[112:115], v[120:123], v[32:47]
    v_mfma_f32_32x32x16_bf16 v[16:31], v[100:103], v[108:111], v[16:31]
    v_mfma_f32_32x32x16_bf16 v[32:47], v[116:119], v[124:127], v[32:47]
    v_subrev_u32 v2, 256, v2
    v_subrev_u32 v5, 256, v5
    v_subrev_u32 v3, 64, v3
    v_subrev_u32 v6, 64, v6
    s_sub_u32 s12, s12, 1
    s_cmp_lg_u32 s12, 0
    s_cbranch_scc1 K2_CLOOP
K2_CDONE:
    v_mov_b32 v8, 163832
    v_mov_b32 v9, 1
    s_waitcnt lgkmcnt(0)
    s_mov_b64 exec, 1
    ds_add_u32 v8, v9 offset:4
    s_mov_b64 exec, -1
    s_cmp_eq_u32 s19, 3
    s_cbranch_scc1 K2_Y2
    v_add_f32 v16, v16, v32
    v_add_f32 v17, v17, v33
    v_add_f32 v18, v18, v34
    v_add_f32 v19, v19, v35
    v_add_f32 v20, v20, v36
    v_add_f32 v21, v21, v37
    v_add_f32 v22, v22, v38
    v_add_f32 v23, v23, v39
    v_add_f32 v24, v24, v40
    v_add_f32 v25, v25, v41
    v_add_f32 v26, v26, v42
    v_add_f32 v27, v27, v43
    v_add_f32 v28, v28, v44
    v_add_f32 v29, v29, v45
    v_add_f32 v30, v30, v46
    v_add_f32 v31, v31, v47
    s_add_u32 s25, s25, s30
    v_cvt_pk_bf16_f32 v16, v16, v17
    v_cvt_pk_bf16_f32 v17, v18, v19
    v_cvt_pk_bf16_f32 v18, v20, v21
    v_cvt_pk_bf16_f32 v19, v22, v23
    v_cvt_pk_bf16_f32 v20, v24, v25
    v_cvt_pk_bf16_f32 v21, v26, v27
    v_cvt_pk_bf16_f32 v22, v28, v29
    v_cvt_pk_bf16_f32 v23, v30, v31
    s_mov_b32 vcc_lo, 0x33333333
    s_mov_b32 vcc_hi, 0x33333333
    v_cndmask_b32_dpp v24, v20, v16, vcc quad_perm:[2,3,0,1] row_mask:0xf bank_mask:0xf
    v_cndmask_b32_dpp v25, v21, v17, vcc quad_perm:[2,3,0,1] row_mask:0xf bank_mask:0xf
    v_cndmask_b32_dpp v26, v22, v18, vcc quad_perm:[2,3,0,1] row_mask:0xf bank_mask:0xf
    v_cndmask_b32_dpp v27, v23, v19, vcc quad_perm:[2,3,0,1] row_mask:0xf bank_mask:0xf
    s_not_b64 vcc, vcc
    v_cndmask_b32_dpp v28, v16, v20, vcc quad_perm:[2,3,0,1] row_mask:0xf bank_mask:0xf
    v_cndmask_b32_dpp v29, v17, v21, vcc quad_perm:[2,3,0,1] row_mask:0xf bank_mask:0xf
    v_cndmask_b32_dpp v30, v18, v22, vcc quad_perm:[2,3,0,1] row_mask:0xf bank_mask:0xf
    v_cndmask_b32_dpp v31, v19, v23, vcc quad_perm:[2,3,0,1] row_mask:0xf bank_mask:0xf
    s_add_u32 s26, s25, 81920
    buffer_store_dwordx4 v[24:27], v4, s[8:11], s25 offen offset:0 sc1
    buffer_store_dwordx4 v[28:31], v4, s[8:11], s26 offen offset:0 sc1
    s_branch K2_YD
K2_Y2:
    v_cvt_pk_bf16_f32 v16, v16, v17
    v_cvt_pk_bf16_f32 v17, v18, v19
    v_cvt_pk_bf16_f32 v18, v20, v21
    v_cvt_pk_bf16_f32 v19, v22, v23
    v_cvt_pk_bf16_f32 v20, v24, v25
    v_cvt_pk_bf16_f32 v21, v26, v27
    v_cvt_pk_bf16_f32 v22, v28, v29
    v_cvt_pk_bf16_f32 v23, v30, v31
    s_mov_b32 vcc_lo, 0x33333333
    s_mov_b32 vcc_hi, 0x33333333
    v_cndmask_b32_dpp v24, v20, v16, vcc quad_perm:[2,3,0,1] row_mask:0xf bank_mask:0xf
    v_cndmask_b32_dpp v25, v21, v17, vcc quad_perm:[2,3,0,1] row_mask:0xf bank_mask:0xf
    v_cndmask_b32_dpp v26, v22, v18, vcc quad_perm:[2,3,0,1] row_mask:0xf bank_mask:0xf
    v_cndmask_b32_dpp v27, v23, v19, vcc quad_perm:[2,3,0,1] row_mask:0xf bank_mask:0xf
    s_not_b64 vcc, vcc
    v_cndmask_b32_dpp v28, v16, v20, vcc quad_perm:[2,3,0,1] row_mask:0xf bank_mask:0xf
    v_cndmask_b32_dpp v29, v17, v21, vcc quad_perm:[2,3,0,1] row_mask:0xf bank_mask:0xf
    v_cndmask_b32_dpp v30, v18, v22, vcc quad_perm:[2,3,0,1] row_mask:0xf bank_mask:0xf
    v_cndmask_b32_dpp v31, v19, v23, vcc quad_perm:[2,3,0,1] row_mask:0xf bank_mask:0xf
    s_add_u32 s26, s25, 81920
    buffer_store_dwordx4 v[24:27], v4, s[8:11], s25 offen offset:0 sc1
    buffer_store_dwordx4 v[28:31], v4, s[8:11], s26 offen offset:0 sc1
    v_cvt_pk_bf16_f32 v32, v32, v33
    v_cvt_pk_bf16_f32 v33, v34, v35
    v_cvt_pk_bf16_f32 v34, v36, v37
    v_cvt_pk_bf16_f32 v35, v38, v39
    v_cvt_pk_bf16_f32 v36, v40, v41
    v_cvt_pk_bf16_f32 v37, v42, v43
    v_cvt_pk_bf16_f32 v38, v44, v45
    v_cvt_pk_bf16_f32 v39, v46, v47
    s_mov_b32 vcc_lo, 0x33333333
    s_mov_b32 vcc_hi, 0x33333333
    v_cndmask_b32_dpp v40, v36, v32, vcc quad_perm:[2,3,0,1] row_mask:0xf bank_mask:0xf
    v_cndmask_b32_dpp v41, v37, v33, vcc quad_perm:[2,3,0,1] row_mask:0xf bank_mask:0xf
    v_cndmask_b32_dpp v42, v38, v34, vcc quad_perm:[2,3,0,1] row_mask:0xf bank_mask:0xf
    v_cndmask_b32_dpp v43, v39, v35, vcc quad_perm:[2,3,0,1] row_mask:0xf bank_mask:0xf
    s_not_b64 vcc, vcc
    v_cndmask_b32_dpp v44, v32, v36, vcc quad_perm:[2,3,0,1] row_mask:0xf bank_mask:0xf
    v_cndmask_b32_dpp v45, v33, v37, vcc quad_perm:[2,3,0,1] row_mask:0xf bank_mask:0xf
    v_cndmask_b32_dpp v46, v34, v38, vcc quad_perm:[2,3,0,1] row_mask:0xf bank_mask:0xf
    v_cndmask_b32_dpp v47, v35, v39, vcc quad_perm:[2,3,0,1] row_mask:0xf bank_mask:0xf
    s_add_u32 s26, s25, 81920
    buffer_store_dwordx4 v[40:43], v4, s[8:11], s25 offen offset:128 sc1
    buffer_store_dwordx4 v[44:47], v4, s[8:11], s26 offen offset:128 sc1
K2_YD:
K2_CSYNC:
    ds_read_b32 v10, v8 offset:4
    s_waitcnt lgkmcnt(0)
    v_readfirstlane_b32 s28, v10
    s_nop 0
    s_cmp_eq_u32 s28, 4
    s_cbranch_scc1 K2_CSYNCD
    s_sleep 4
    s_branch K2_CSYNC
K2_CSYNCD:
    s_and_b32 s40, s2, 7
    s_lshl_b32 s40, s40, 2
    s_bfe_u32 s41, s2, 0x20003
    s_add_u32 s40, s40, s41
    s_lshr_b32 s41, s2, 5
    s_mov_b32 s36, s6
    s_and_b32 s37, s7, 0xffff
    s_mov_b32 s38, 2621440
    s_mov_b32 s39, 0x20000
    s_lshl_b32 s42, s3, 2
    s_lshl_b32 s43, s40, 8
    s_add_u32 s43, s43, 20971520
    s_mul_i32 s44, s40, 81920
    s_mul_i32 s45, s41, 160
    s_add_u32 s44, s44, s45
    v_lshrrev_b32 v8, 4, v0
    v_add_u32 v8, s42, v8
    v_and_b32 v9, 15, v0
    v_lshlrev_b32 v2, 9, v8
    v_lshl_add_u32 v2, v9, 4, v2
    v_mul_u32_u24 v10, 205, v8
    v_lshrrev_b32 v10, 11, v10
    v_mul_u32_u24 v11, 10, v10
    v_sub_u32 v11, v8, v11
    v_lshlrev_b32 v3, 10, v11
    v_lshl_add_u32 v3, v10, 5, v3
    v_lshrrev_b32 v8, 2, v9
    v_lshl_add_u32 v3, v8, 7, v3
    v_and_b32 v8, 3, v0
    v_lshl_add_u32 v3, v8, 3, v3
    v_add_u32 v3, 81920, v3
    v_lshl_add_u32 v10, v10, 4, v9
    v_mul_u32_u24 v4, 1280, v10
    v_lshl_add_u32 v4, v11, 4, v4
    v_lshlrev_b32 v5, 2, v10
    v_lshlrev_b32 v7, 4, v0
    s_mul_i32 s24, s41, 102400
    s_add_u32 s24, s24, 19922944
    s_mul_i32 s28, s19, 19456
    s_min_u32 s28, s28, 57344
    s_add_u32 m0, s28, 81920
    s_add_u32 s29, s28, s24
    buffer_load_dwordx4 v7, s[8:11], s29 offen offset:0 lds
    buffer_load_dwordx4 v7, s[8:11], s29 offen offset:1024 lds
    buffer_load_dwordx4 v7, s[8:11], s29 offen offset:2048 lds
    buffer_load_dwordx4 v7, s[8:11], s29 offen offset:3072 lds
    s_add_u32 m0, s28, 86016
    s_add_u32 s29, s28, s24
    s_add_u32 s29, s29, 4096
    buffer_load_dwordx4 v7, s[8:11], s29 offen offset:0 lds
    buffer_load_dwordx4 v7, s[8:11], s29 offen offset:1024 lds
    buffer_load_dwordx4 v7, s[8:11], s29 offen offset:2048 lds
    buffer_load_dwordx4 v7, s[8:11], s29 offen offset:3072 lds
    s_add_u32 m0, s28, 90112
    s_add_u32 s29, s28, s24
    s_add_u32 s29, s29, 8192
    buffer_load_dwordx4 v7, s[8:11], s29 offen offset:0 lds
    buffer_load_dwordx4 v7, s[8:11], s29 offen offset:1024 lds
    buffer_load_dwordx4 v7, s[8:11], s29 offen offset:2048 lds
    buffer_load_dwordx4 v7, s[8:11], s29 offen offset:3072 lds
    s_add_u32 m0, s28, 94208
    s_add_u32 s29, s28, s24
    s_add_u32 s29, s29, 12288
    buffer_load_dwordx4 v7, s[8:11], s29 offen offset:0 lds
    buffer_load_dwordx4 v7, s[8:11], s29 offen offset:1024 lds
    buffer_load_dwordx4 v7, s[8:11], s29 offen offset:2048 lds
    buffer_load_dwordx4 v7, s[8:11], s29 offen offset:3072 lds
    s_add_u32 m0, s28, 98304
    s_add_u32 s29, s28, s24
    s_add_u32 s29, s29, 16384
    buffer_load_dwordx4 v7, s[8:11], s29 offen offset:0 lds
    buffer_load_dwordx4 v7, s[8:11], s29 offen offset:1024 lds
    buffer_load_dwordx4 v7, s[8:11], s29 offen offset:2048 lds
    buffer_load_dword v5, v5, s[8:11], s43 offen
    s_mul_i32 s34, s40, 81920
    s_mul_i32 s25, s41, 10240
    s_add_u32 s34, s34, s25
    s_mul_i32 s25, s19, 2560
    s_add_u32 s34, s34, s25
    s_add_u32 s34, s34, 13631488
    s_add_u32 s25, s25, 81920
    v_add_u32 v6, s25, v7
    s_and_b32 s26, s2, 7
    s_lshl_b32 s26, s26, 5
    v_and_b32 v9, 31, v0
    v_add_u32 v8, s26, v9
    s_and_b32 s27, s2, 0xe0
    v_add_u32 v9, s27, v9
    v_cmp_gt_u32 vcc, 32, v0
    s_nop 1
    v_cndmask_b32 v8, v9, v8, vcc
    v_cmp_eq_u32 s[46:47], s2, v8
    v_lshlrev_b32 v8, 2, v8
    s_mov_b32 s30, 21954560
    s_mov_b32 s31, 0x40000
    s_lshl_b32 s35, s2, 2
    s_add_u32 s35, s35, 21954560
    v_mov_b32 v10, 0
    v_mov_b32 v11, 1
    s_waitcnt vmcnt(0)
    s_barrier
    s_cmp_lg_u32 s19, 1
    s_cbranch_scc1 K2_NOPUB
    s_mov_b64 exec, 1
    buffer_store_dword v11, v10, s[8:11], s35 offen sc1
    s_mov_b64 exec, -1
K2_NOPUB:
    s_barrier
    s_mul_i32 s28, s19, 6144
    s_add_u32 m0, s28, 56320
    s_add_u32 s29, s28, s24
    s_add_u32 s29, s29, 76800
    buffer_load_dwordx4 v7, s[8:11], s29 offen offset:0 lds
    buffer_load_dwordx4 v7, s[8:11], s29 offen offset:1024 lds
    buffer_load_dwordx4 v7, s[8:11], s29 offen offset:2048 lds
    buffer_load_dwordx4 v7, s[8:11], s29 offen offset:3072 lds
    s_add_u32 m0, s28, 60416
    s_add_u32 s29, s28, s24
    s_add_u32 s29, s29, 80896
    buffer_load_dwordx4 v7, s[8:11], s29 offen offset:0 lds
    buffer_load_dwordx4 v7, s[8:11], s29 offen offset:1024 lds
    buffer_load_dwordx4 v7, s[8:11], s29 offen offset:2048 lds
    s_cmp_lg_u32 s19, 0
    s_cbranch_scc1 K2_POLLD
K2_POLL:
    buffer_load_dword v9, v8, s[8:11], s30 offen sc1
    s_sub_u32 s31, s31, 1
    s_waitcnt vmcnt(0)
    v_cmp_eq_u32 vcc, 1, v9
    s_nop 0
    s_or_b64 vcc, vcc, s[46:47]
    s_cmp_eq_u64 vcc, -1
    s_cbranch_scc1 K2_POLLD
    s_cmp_eq_u32 s31, 0
    s_cbranch_scc1 K2_POLLD
    s_sleep 1
    s_branch K2_POLL
K2_POLLD:
    s_waitcnt vmcnt(0)
    s_barrier
    buffer_load_dwordx4 v[16:19], v7, s[8:11], s34 offen offset:0 sc1
    buffer_load_dwordx4 v[20:23], v7, s[8:11], s34 offen offset:1024 sc1
    s_mov_b64 exec, 0xffffffff
    buffer_load_dwordx4 v[24:27], v7, s[8:11], s34 offen offset:2048 sc1
    s_mov_b64 exec, -1
    s_waitcnt vmcnt(2)
    ds_write_b128 v6, v[16:19] offset:0
    s_waitcnt vmcnt(1)
    ds_write_b128 v6, v[20:23] offset:1024
    s_mov_b64 exec, 0xffffffff
    s_waitcnt vmcnt(0)
    ds_write_b128 v6, v[24:27] offset:2048
    s_mov_b64 exec, -1
K2_FINAL:
    s_waitcnt lgkmcnt(0)
    s_barrier
    s_cmp_ge_u32 s3, 10
    s_cbranch_scc1 K2_DONE
    ds_read_b64_tr_b16 v[48:49], v3 offset:0
    ds_read_b64_tr_b16 v[50:51], v3 offset:512
    v_add_u32 v3, 92160, v2
    ds_read_b128 v[16:19], v2 offset:0
    ds_read_b128 v[20:23], v2 offset:256
    ds_read_b128 v[24:27], v2 offset:20480
    ds_read_b128 v[28:31], v2 offset:20736
    ds_read_b128 v[32:35], v3 offset:0
    ds_read_b128 v[36:39], v3 offset:256
    ds_read_b128 v[40:43], v3 offset:20480
    ds_read_b128 v[44:47], v3 offset:20736
    s_waitcnt vmcnt(0) lgkmcnt(8)
    v_sub_f32 v60, 1.0, v5
    v_lshlrev_b32 v52, 16, v48
    v_and_b32 v53, 0xffff0000, v48
    v_lshlrev_b32 v54, 16, v49
    v_and_b32 v55, 0xffff0000, v49
    v_lshlrev_b32 v56, 16, v50
    v_and_b32 v57, 0xffff0000, v50
    v_lshlrev_b32 v58, 16, v51
    v_and_b32 v59, 0xffff0000, v51
    v_mul_f32 v52, v60, v52
    v_mul_f32 v53, v60, v53
    v_mul_f32 v54, v60, v54
    v_mul_f32 v55, v60, v55
    v_mul_f32 v56, v60, v56
    v_mul_f32 v57, v60, v57
    v_mul_f32 v58, v60, v58
    v_mul_f32 v59, v60, v59
    s_waitcnt lgkmcnt(4)
    v_pk_add_f32 v[16:17], v[16:17], v[24:25]
    v_pk_add_f32 v[18:19], v[18:19], v[26:27]
    v_pk_add_f32 v[20:21], v[20:21], v[28:29]
    v_pk_add_f32 v[22:23], v[22:23], v[30:31]
    s_waitcnt lgkmcnt(0)
    v_pk_add_f32 v[32:33], v[32:33], v[40:41]
    v_pk_add_f32 v[34:35], v[34:35], v[42:43]
    v_pk_add_f32 v[36:37], v[36:37], v[44:45]
    v_pk_add_f32 v[38:39], v[38:39], v[46:47]
    v_pk_add_f32 v[16:17], v[16:17], v[32:33]
    v_pk_add_f32 v[18:19], v[18:19], v[34:35]
    v_pk_add_f32 v[20:21], v[20:21], v[36:37]
    v_pk_add_f32 v[22:23], v[22:23], v[38:39]
    v_fma_f32 v16, v5, v16, v52
    v_fma_f32 v17, v5, v17, v53
    v_fma_f32 v18, v5, v18, v54
    v_fma_f32 v19, v5, v19, v55
    v_fma_f32 v20, v5, v20, v56
    v_fma_f32 v21, v5, v21, v57
    v_fma_f32 v22, v5, v22, v58
    v_fma_f32 v23, v5, v23, v59
    v_cvt_pk_bf16_f32 v16, v16, v17
    v_cvt_pk_bf16_f32 v17, v18, v19
    v_cvt_pk_bf16_f32 v18, v20, v21
    v_cvt_pk_bf16_f32 v19, v22, v23
    buffer_store_dwordx4 v[16:19], v4, s[36:39], s44 offen
K2_DONE:
.set HOP_T_0, K2_WARMD
.set HOPE_T_0, K2_WARMD
.set HOPE_T_1, K2_WARMD
.set HOPE_T_2, K2_WARMD
.set HOPE_T_3, K2_WARMD
    s_endpgm
K2_EXIT:
    s_endpgm
.section .rodata,"a"
.p2align 6
.amdhsa_kernel k2_kernel
  .amdhsa_next_free_vgpr 168
  .amdhsa_next_free_sgpr 102
  .amdhsa_accum_offset 168
  .amdhsa_group_segment_fixed_size 0
  .amdhsa_kernarg_size 128
  .amdhsa_user_sgpr_count 2
  .amdhsa_user_sgpr_kernarg_segment_ptr 1
  .amdhsa_system_sgpr_workgroup_id_x 1
.end_amdhsa_kernel
```
